```python
import torch

def _softmax(x, axis=-1):
    return torch.softmax(x, dim=axis)
def _gelu(x):
    return torch.nn.functional.gelu(x, approximate="tanh")
def _silu(x):
    return torch.nn.functional.silu(x)
def _sigmoid(x):
    return torch.sigmoid(x)
def _layernorm(x, axis=-1, eps=1e-5):
    m = x.mean(dim=axis, keepdim=True)
    v = x.var(dim=axis, keepdim=True, unbiased=False)
    return (x - m) / torch.sqrt(v + eps)
def _scatter_add(tgt, idx, src, axis=0):
    return tgt.clone().index_add_(axis, idx, src)
def _segment_sum(src, seg, n):
    out = torch.zeros((n,) + src.shape[1:], dtype=src.dtype)
    return out.index_add_(0, seg, src)
def _pad(x, pw):
    flat = tuple(v for pair in reversed(pw) for v in pair)
    return torch.nn.functional.pad(x, flat)

kernel_name = 'gated_mix__gqa_block_cached__moe_arch_mod__decode'

def setup_inputs():

    _w = (lambda a: (lambda t: t.to(torch.bfloat16) if t.is_floating_point() else t)(torch.as_tensor(a)))
    def _A_setup():
        B, Sq, D = 1, 1, 1024
        Hq, Hkv, Sk, Dh = 32, 4, 65536, 128
        assert Hq % Hkv == 0, (Hq, Hkv)
        return {
            "x": _w((lambda *s: torch.randn(*s, dtype=torch.bfloat16) * 0.05)(B, Sq, D)),
            "k_cache": _w((lambda *s: torch.randn(*s, dtype=torch.bfloat16) * 3.2)(B, Hkv, Sk, Dh)),
            "v_cache": _w((lambda *s: torch.randn(*s, dtype=torch.bfloat16) * 1.6)(B, Hkv, Sk, Dh)),
            "wq": _w((lambda *s: torch.randn(*s, dtype=torch.bfloat16) * 3.2)(D, Hq * Dh) * (D ** -0.5)),
            "wo": _w((lambda *s: torch.randn(*s, dtype=torch.bfloat16) * 1.6)(Hq * Dh, D) * ((Hq * Dh) ** -0.5)),
        }
    _A_in = _A_setup()

    def _B_setup():
        B, S, D, F, C = 1, 1, 1024, 3584, 1
        return {
            "x": _w((lambda *s: torch.randn(*s, dtype=torch.bfloat16) * 0.05)(B, S, D)),
            "w_r": _w((lambda *s: torch.randn(*s, dtype=torch.bfloat16) * 0.05)(D)),
            "w_gate": _w((lambda *s: torch.randn(*s, dtype=torch.bfloat16) * 0.05)(D, F)),
            "w_up": _w((lambda *s: torch.randn(*s, dtype=torch.bfloat16) * 0.05)(D, F)),
            "w_down": _w((lambda *s: torch.randn(*s, dtype=torch.bfloat16) * 0.05)(F, D)),
        }
    _B_in = _B_setup()

    return {
        "A_x": _A_in["x"],
        "A_k_cache": _A_in["k_cache"],
        "A_v_cache": _A_in["v_cache"],
        "A_wq": _A_in["wq"],
        "A_wo": _A_in["wo"],
        "B_x": _B_in["x"],
        "B_w_r": _B_in["w_r"],
        "B_w_gate": _B_in["w_gate"],
        "B_w_up": _B_in["w_up"],
        "B_w_down": _B_in["w_down"],
        "gate_w": _w((lambda *s: torch.randn(*s, dtype=torch.bfloat16) * 0.05)(1024) * 16.0),
    }

def reference(A_x, A_k_cache, A_v_cache, A_wq, A_wo, B_x, B_w_r, B_w_gate, B_w_up, B_w_down, gate_w):
    def _A_ref(x, k_cache, v_cache, wq, wo):
        B, Sq, D = x.shape
        Hq, Dh = 32, 128
        Hkv = k_cache.shape[1]
        rep = Hq // Hkv
        q = (lambda x, *d: x.permute(*d))((x @ wq).reshape(B, Sq, Hq, Dh), 0, 2, 1, 3)
        k = (lambda x, n, axis: torch.repeat_interleave(x, n, dim=axis))(k_cache, rep, axis=1)
        v = (lambda x, n, axis: torch.repeat_interleave(x, n, dim=axis))(v_cache, rep, axis=1)
        scores = torch.einsum("bhqd,bhkd->bhqk", q, k) * (Dh ** -0.5)
        p = _softmax(scores, axis=-1)
        o = torch.einsum("bhqk,bhkd->bhqd", p, v)
        return (lambda x, *d: x.permute(*d))(o, 0, 2, 1, 3).reshape(B, Sq, Hq * Dh) @ wo

    def _B_ref(x, w_r, w_gate, w_up, w_down):
        B, S, D = x.shape
        C = 1
        r = x @ w_r
        idx = torch.argsort(-r, axis=-1)[:, :C]
        idx_e = (lambda x, n, axis: torch.repeat_interleave(x, n, dim=axis))(idx.reshape(B, C, 1), D, axis=2)
        x_sel = (lambda x, i, axis: torch.take_along_dim(x, i, dim=axis))(x, idx_e, axis=1)
        g = _silu(x_sel @ w_gate)
        u = x_sel @ w_up
        y = (g * u) @ w_down
        r_sel = _sigmoid((lambda x, i, axis: torch.take_along_dim(x, i, dim=axis))(r, idx, axis=1))
        y = y * r_sel.reshape(B, C, 1)
        b_off = (torch.arange(B) * S).reshape(B, 1)
        flat_idx = (idx + b_off).reshape(B * C)
        zero = (x * 0.0).reshape(B * S, D)
        upd = _scatter_add(zero, flat_idx, y.reshape(B * C, D), axis=0)
        return x + upd.reshape(B, S, D)

    x = A_x
    g = _sigmoid((x * gate_w).sum(-1, keepdims=True))
    a = _A_ref(x, A_k_cache, A_v_cache, A_wq, A_wo)
    b = _B_ref(x, B_w_r, B_w_gate, B_w_up, B_w_down)
    return g * a + (1 - g) * b
```

```asm
; @launch grid=(256,1,1) block=(768,1,1) lds=39040
.amdgcn_target "amdgcn-amd-amdhsa--gfx950"
.text
.globl gated_mix__gqa_block_cached__moe_arch_mod__decode_kernel
.p2align 8
.type gated_mix__gqa_block_cached__moe_arch_mod__decode_kernel,@function
gated_mix__gqa_block_cached__moe_arch_mod__decode_kernel:
    s_cmp_ge_u32 s2, 256
    s_cbranch_scc1 k_end
    s_load_dwordx2 s[12:13], s[0:1], 8
    s_load_dwordx2 s[16:17], s[0:1], 16
    s_load_dwordx2 s[56:57], s[0:1], 104
    v_lshrrev_b32 v1, 6, v0
    v_and_b32 v0, 63, v0
    v_readfirstlane_b32 s60, v1
    s_bfe_u32 s61, s2, 0x20003
    s_lshl_b32 s61, s61, 6
    s_lshr_b32 s62, s2, 5
    s_lshl_b32 s62, s62, 3
    s_add_u32 s61, s61, s62
    s_and_b32 s62, s2, 7
    s_add_u32 s61, s61, s62
    s_mov_b32 s90, 0x400000
    s_mov_b32 s91, 0x20000
    s_cmp_lt_u32 s60, 4
    s_cbranch_scc1 k_svc
    s_sub_u32 s60, s60, 4
    s_mov_b32 s14, 0x4000000
    s_mov_b32 s15, 0x00020000
    v_lshrrev_b32 v2, 4, v0
    v_bfe_u32 v3, v0, 2, 2
    v_lshlrev_b32 v3, 8, v3
    v_lshl_add_u32 v3, v2, 6, v3
    v_and_b32 v6, 3, v0
    v_lshl_add_u32 v3, v6, 4, v3
    s_lshr_b32 s73, s61, 6
    s_and_b32 s63, s61, 63
    s_mul_i32 s64, s63, 24
    s_add_u32 s64, s64, s60
    s_lshl_b32 s64, s64, 13
    s_lshl_b32 s97, s73, 24
    s_add_u32 s64, s64, s97
    s_add_u32 s65, s64, 4096
    s_setprio 1
    s_cmp_lg_u32 s63, 56
    s_cbranch_scc1 a_nb
    s_barrier
a_nb:
    s_waitcnt lgkmcnt(0)
    s_and_b32 s13, s13, 0xffff
    buffer_load_dwordx4 v[8:11], v3, s[12:15], s64 offen offset:0 nt
    buffer_load_dwordx4 v[12:15], v3, s[12:15], s64 offen offset:1024 nt
    buffer_load_dwordx4 v[16:19], v3, s[12:15], s64 offen offset:2048 nt
    buffer_load_dwordx4 v[20:23], v3, s[12:15], s64 offen offset:3072 nt
    buffer_load_dwordx4 v[24:27], v3, s[12:15], s65 offen offset:0 nt
    buffer_load_dwordx4 v[28:31], v3, s[12:15], s65 offen offset:1024 nt
    buffer_load_dwordx4 v[32:35], v3, s[12:15], s65 offen offset:2048 nt
    buffer_load_dwordx4 v[36:39], v3, s[12:15], s65 offen offset:3072 nt
    s_add_u32 s66, s64, 65536
    s_add_u32 s67, s64, 69632
    s_add_u32 s68, s64, 131072
    s_add_u32 s69, s64, 135168
    s_load_dwordx2 s[48:49], s[0:1], 88
    s_mov_b32 s18, 0x4000000
    s_mov_b32 s19, 0x00020000
    s_mov_b32 s58, 0x10000000
    s_mov_b32 s59, 0x00020000
    s_mov_b32 s50, 0x800
    s_mov_b32 s51, 0x00020000
    s_and_b32 s17, s17, 0xffff
    s_and_b32 s57, s57, 0xffff
    v_and_b32 v1, 15, v0
    v_lshlrev_b32 v4, 4, v0
    v_mov_b32 v5, 0
    s_mov_b32 s76, 0x05040100
    s_mov_b32 s77, 0x07060302
    s_mov_b32 s78, 0x3e0293ee
    v_and_b32 v6, 7, v1
    v_mul_u32_u24 v136, 272, v6
    v_lshrrev_b32 v7, 3, v1
    v_lshl_add_u32 v7, v2, 2, v7
    v_lshl_add_u32 v136, v7, 4, v136
    s_lshr_b32 s62, s63, 3
    s_add_u32 s62, s62, s63
    s_and_b32 s62, s62, 3
    s_lshl_b32 s75, s73, 3
    s_add_u32 s75, s75, s62
    s_lshl_b32 s75, s75, 7
    s_add_u32 s75, s75, 0x30000
    s_add_u32 s62, s62, 1536
    s_lshl_b32 s62, s62, 13
    s_add_u32 s97, s97, s62
    v_mov_b32 v162, -1
    s_mov_b32 s98, s60
    s_waitcnt lgkmcnt(0)
    s_and_b32 s49, s49, 0xffff
    s_cmp_eq_u32 s63, 56
    s_cbranch_scc1 a_nb2
    s_barrier
a_nb2:
    s_cmp_ge_u32 s60, 4
    s_cbranch_scc1 a_py
    s_waitcnt vmcnt(7)
    buffer_load_dwordx4 v[40:43], v3, s[12:15], s66 offen offset:0 nt
    s_waitcnt vmcnt(7)
    buffer_load_dwordx4 v[44:47], v3, s[12:15], s66 offen offset:1024 nt
    s_waitcnt vmcnt(7)
    buffer_load_dwordx4 v[48:51], v3, s[12:15], s66 offen offset:2048 nt
    s_waitcnt vmcnt(7)
    buffer_load_dwordx4 v[52:55], v3, s[12:15], s66 offen offset:3072 nt
    s_waitcnt vmcnt(7)
    buffer_load_dwordx4 v[56:59], v3, s[12:15], s67 offen offset:0 nt
    s_waitcnt vmcnt(7)
    buffer_load_dwordx4 v[60:63], v3, s[12:15], s67 offen offset:1024 nt
    s_waitcnt vmcnt(7)
    buffer_load_dwordx4 v[64:67], v3, s[12:15], s67 offen offset:2048 nt
    s_waitcnt vmcnt(7)
    buffer_load_dwordx4 v[68:71], v3, s[12:15], s67 offen offset:3072 nt
    s_waitcnt vmcnt(7)
    buffer_load_dwordx4 v[72:75], v3, s[12:15], s68 offen offset:0 nt
    s_waitcnt vmcnt(7)
    buffer_load_dwordx4 v[76:79], v3, s[12:15], s68 offen offset:1024 nt
    s_waitcnt vmcnt(7)
    buffer_load_dwordx4 v[80:83], v3, s[12:15], s68 offen offset:2048 nt
    s_waitcnt vmcnt(7)
    buffer_load_dwordx4 v[84:87], v3, s[12:15], s68 offen offset:3072 nt
    s_waitcnt vmcnt(7)
    buffer_load_dwordx4 v[88:91], v3, s[12:15], s69 offen offset:0 nt
    s_waitcnt vmcnt(7)
    buffer_load_dwordx4 v[92:95], v3, s[12:15], s69 offen offset:1024 nt
    s_waitcnt vmcnt(7)
    buffer_load_dwordx4 v[96:99], v3, s[12:15], s69 offen offset:2048 nt
    s_waitcnt vmcnt(7)
    buffer_load_dwordx4 v[100:103], v3, s[12:15], s69 offen offset:3072 nt
    s_waitcnt vmcnt(7)
    buffer_load_dwordx4 v[104:107], v4, s[16:19], s64 offen offset:0 nt
    s_waitcnt vmcnt(7)
    buffer_load_dwordx4 v[108:111], v4, s[16:19], s64 offen offset:1024 nt
    s_waitcnt vmcnt(7)
    buffer_load_dwordx4 v[112:115], v4, s[16:19], s64 offen offset:2048 nt
    s_waitcnt vmcnt(7)
    buffer_load_dwordx4 v[116:119], v4, s[16:19], s64 offen offset:3072 nt
    s_waitcnt vmcnt(7)
    buffer_load_dwordx4 v[120:123], v4, s[16:19], s65 offen offset:0 nt
    s_waitcnt vmcnt(7)
    buffer_load_dwordx4 v[124:127], v4, s[16:19], s65 offen offset:1024 nt
    s_waitcnt vmcnt(7)
    buffer_load_dwordx4 v[128:131], v4, s[16:19], s65 offen offset:2048 nt
    s_waitcnt vmcnt(7)
    buffer_load_dwordx4 v[132:135], v4, s[16:19], s65 offen offset:3072 nt
    s_branch a_pd
a_py:
    buffer_load_dwordx4 v[40:43], v3, s[12:15], s66 offen offset:0 nt
    buffer_load_dwordx4 v[44:47], v3, s[12:15], s66 offen offset:1024 nt
    buffer_load_dwordx4 v[48:51], v3, s[12:15], s66 offen offset:2048 nt
    buffer_load_dwordx4 v[52:55], v3, s[12:15], s66 offen offset:3072 nt
    buffer_load_dwordx4 v[56:59], v3, s[12:15], s67 offen offset:0 nt
    buffer_load_dwordx4 v[60:63], v3, s[12:15], s67 offen offset:1024 nt
    buffer_load_dwordx4 v[64:67], v3, s[12:15], s67 offen offset:2048 nt
    buffer_load_dwordx4 v[68:71], v3, s[12:15], s67 offen offset:3072 nt
    s_waitcnt vmcnt(15)
    buffer_load_dwordx4 v[72:75], v3, s[12:15], s68 offen offset:0 nt
    s_waitcnt vmcnt(15)
    buffer_load_dwordx4 v[76:79], v3, s[12:15], s68 offen offset:1024 nt
    s_waitcnt vmcnt(15)
    buffer_load_dwordx4 v[80:83], v3, s[12:15], s68 offen offset:2048 nt
    s_waitcnt vmcnt(15)
    buffer_load_dwordx4 v[84:87], v3, s[12:15], s68 offen offset:3072 nt
    s_waitcnt vmcnt(15)
    buffer_load_dwordx4 v[88:91], v3, s[12:15], s69 offen offset:0 nt
    s_waitcnt vmcnt(15)
    buffer_load_dwordx4 v[92:95], v3, s[12:15], s69 offen offset:1024 nt
    s_waitcnt vmcnt(15)
    buffer_load_dwordx4 v[96:99], v3, s[12:15], s69 offen offset:2048 nt
    s_waitcnt vmcnt(15)
    buffer_load_dwordx4 v[100:103], v3, s[12:15], s69 offen offset:3072 nt
    s_waitcnt vmcnt(15)
    buffer_load_dwordx4 v[104:107], v4, s[16:19], s64 offen offset:0 nt
    s_waitcnt vmcnt(15)
    buffer_load_dwordx4 v[108:111], v4, s[16:19], s64 offen offset:1024 nt
    s_waitcnt vmcnt(15)
    buffer_load_dwordx4 v[112:115], v4, s[16:19], s64 offen offset:2048 nt
    s_waitcnt vmcnt(15)
    buffer_load_dwordx4 v[116:119], v4, s[16:19], s64 offen offset:3072 nt
    s_waitcnt vmcnt(15)
    buffer_load_dwordx4 v[120:123], v4, s[16:19], s65 offen offset:0 nt
    s_waitcnt vmcnt(15)
    buffer_load_dwordx4 v[124:127], v4, s[16:19], s65 offen offset:1024 nt
    s_waitcnt vmcnt(15)
    buffer_load_dwordx4 v[128:131], v4, s[16:19], s65 offen offset:2048 nt
    s_waitcnt vmcnt(15)
    buffer_load_dwordx4 v[132:135], v4, s[16:19], s65 offen offset:3072 nt
a_pd:
a_sq:
    ds_read_b32 v6, v5 offset:8
    s_waitcnt lgkmcnt(0)
    v_readfirstlane_b32 s92, v6
    s_cmp_ge_u32 s92, 4
    s_cbranch_scc1 a_sq_d
    s_sub_u32 s90, s90, 1
    s_cbranch_scc0 a_sq
    s_endpgm
a_sq_d:
    ds_read_b128 v[152:155], v136 offset:1024
    ds_read_b128 v[156:159], v136 offset:1056
    s_waitcnt lgkmcnt(0)
    v_mfma_f32_16x16x32_bf16 v[136:139], v[8:11], v[152:155], 0
    v_mfma_f32_16x16x32_bf16 v[140:143], v[8:11], v[156:159], 0
    v_mfma_f32_16x16x32_bf16 v[144:147], v[24:27], v[152:155], 0
    v_mfma_f32_16x16x32_bf16 v[148:151], v[24:27], v[156:159], 0
    s_nop 5
    v_add_f32 v6, v136, v142
    v_add_f32 v7, v137, v143
    v_add_f32_dpp v6, v145, v151 quad_perm:[0,1,2,3] row_mask:0xf bank_mask:0xc
    v_add_f32_dpp v7, v144, v150 quad_perm:[0,1,2,3] row_mask:0xf bank_mask:0x3
    s_nop 1
    v_add_f32_dpp v164, v7, v6 row_ror:8 row_mask:0xf bank_mask:0xf
    v_mfma_f32_16x16x32_bf16 v[136:139], v[12:15], v[152:155], 0
    v_mfma_f32_16x16x32_bf16 v[140:143], v[12:15], v[156:159], 0
    v_mfma_f32_16x16x32_bf16 v[144:147], v[28:31], v[152:155], 0
    v_mfma_f32_16x16x32_bf16 v[148:151], v[28:31], v[156:159], 0
    s_nop 5
    v_add_f32 v6, v136, v142
    v_add_f32 v7, v137, v143
    v_add_f32_dpp v6, v145, v151 quad_perm:[0,1,2,3] row_mask:0xf bank_mask:0xc
    v_add_f32_dpp v7, v144, v150 quad_perm:[0,1,2,3] row_mask:0xf bank_mask:0x3
    s_nop 1
    v_add_f32_dpp v165, v7, v6 row_ror:8 row_mask:0xf bank_mask:0xf
    v_mfma_f32_16x16x32_bf16 v[136:139], v[16:19], v[152:155], 0
    v_mfma_f32_16x16x32_bf16 v[140:143], v[16:19], v[156:159], 0
    v_mfma_f32_16x16x32_bf16 v[144:147], v[32:35], v[152:155], 0
    v_mfma_f32_16x16x32_bf16 v[148:151], v[32:35], v[156:159], 0
    s_nop 5
    v_add_f32 v6, v136, v142
    v_add_f32 v7, v137, v143
    v_add_f32_dpp v6, v145, v151 quad_perm:[0,1,2,3] row_mask:0xf bank_mask:0xc
    v_add_f32_dpp v7, v144, v150 quad_perm:[0,1,2,3] row_mask:0xf bank_mask:0x3
    s_nop 1
    v_add_f32_dpp v166, v7, v6 row_ror:8 row_mask:0xf bank_mask:0xf
    v_mfma_f32_16x16x32_bf16 v[136:139], v[20:23], v[152:155], 0
    v_mfma_f32_16x16x32_bf16 v[140:143], v[20:23], v[156:159], 0
    v_mfma_f32_16x16x32_bf16 v[144:147], v[36:39], v[152:155], 0
    v_mfma_f32_16x16x32_bf16 v[148:151], v[36:39], v[156:159], 0
    s_nop 5
    v_add_f32 v6, v136, v142
    v_add_f32 v7, v137, v143
    v_add_f32_dpp v6, v145, v151 quad_perm:[0,1,2,3] row_mask:0xf bank_mask:0xc
    v_add_f32_dpp v7, v144, v150 quad_perm:[0,1,2,3] row_mask:0xf bank_mask:0x3
    s_nop 1
    v_add_f32_dpp v167, v7, v6 row_ror:8 row_mask:0xf bank_mask:0xf
    v_mfma_f32_16x16x32_bf16 v[136:139], v[40:43], v[152:155], 0
    v_mfma_f32_16x16x32_bf16 v[140:143], v[40:43], v[156:159], 0
    v_mfma_f32_16x16x32_bf16 v[144:147], v[56:59], v[152:155], 0
    v_mfma_f32_16x16x32_bf16 v[148:151], v[56:59], v[156:159], 0
    s_nop 5
    v_add_f32 v6, v136, v142
    v_add_f32 v7, v137, v143
    v_add_f32_dpp v6, v145, v151 quad_perm:[0,1,2,3] row_mask:0xf bank_mask:0xc
    v_add_f32_dpp v7, v144, v150 quad_perm:[0,1,2,3] row_mask:0xf bank_mask:0x3
    s_nop 1
    v_add_f32_dpp v8, v7, v6 row_ror:8 row_mask:0xf bank_mask:0xf
    buffer_load_dwordx4 v[40:43], v4, s[16:19], s66 offen offset:0 nt
    buffer_load_dwordx4 v[56:59], v4, s[16:19], s67 offen offset:0 nt
    v_mfma_f32_16x16x32_bf16 v[136:139], v[44:47], v[152:155], 0
    v_mfma_f32_16x16x32_bf16 v[140:143], v[44:47], v[156:159], 0
    v_mfma_f32_16x16x32_bf16 v[144:147], v[60:63], v[152:155], 0
    v_mfma_f32_16x16x32_bf16 v[148:151], v[60:63], v[156:159], 0
    s_nop 5
    v_add_f32 v6, v136, v142
    v_add_f32 v7, v137, v143
    v_add_f32_dpp v6, v145, v151 quad_perm:[0,1,2,3] row_mask:0xf bank_mask:0xc
    v_add_f32_dpp v7, v144, v150 quad_perm:[0,1,2,3] row_mask:0xf bank_mask:0x3
    s_nop 1
    v_add_f32_dpp v9, v7, v6 row_ror:8 row_mask:0xf bank_mask:0xf
    buffer_load_dwordx4 v[44:47], v4, s[16:19], s66 offen offset:1024 nt
    buffer_load_dwordx4 v[60:63], v4, s[16:19], s67 offen offset:1024 nt
    v_mfma_f32_16x16x32_bf16 v[136:139], v[48:51], v[152:155], 0
    v_mfma_f32_16x16x32_bf16 v[140:143], v[48:51], v[156:159], 0
    v_mfma_f32_16x16x32_bf16 v[144:147], v[64:67], v[152:155], 0
    v_mfma_f32_16x16x32_bf16 v[148:151], v[64:67], v[156:159], 0
    s_nop 5
    v_add_f32 v6, v136, v142
    v_add_f32 v7, v137, v143
    v_add_f32_dpp v6, v145, v151 quad_perm:[0,1,2,3] row_mask:0xf bank_mask:0xc
    v_add_f32_dpp v7, v144, v150 quad_perm:[0,1,2,3] row_mask:0xf bank_mask:0x3
    s_nop 1
    v_add_f32_dpp v10, v7, v6 row_ror:8 row_mask:0xf bank_mask:0xf
    buffer_load_dwordx4 v[48:51], v4, s[16:19], s66 offen offset:2048 nt
    buffer_load_dwordx4 v[64:67], v4, s[16:19], s67 offen offset:2048 nt
    v_mfma_f32_16x16x32_bf16 v[136:139], v[52:55], v[152:155], 0
    v_mfma_f32_16x16x32_bf16 v[140:143], v[52:55], v[156:159], 0
    v_mfma_f32_16x16x32_bf16 v[144:147], v[68:71], v[152:155], 0
    v_mfma_f32_16x16x32_bf16 v[148:151], v[68:71], v[156:159], 0
    s_nop 5
    v_add_f32 v6, v136, v142
    v_add_f32 v7, v137, v143
    v_add_f32_dpp v6, v145, v151 quad_perm:[0,1,2,3] row_mask:0xf bank_mask:0xc
    v_add_f32_dpp v7, v144, v150 quad_perm:[0,1,2,3] row_mask:0xf bank_mask:0x3
    s_nop 1
    v_add_f32_dpp v11, v7, v6 row_ror:8 row_mask:0xf bank_mask:0xf
    buffer_load_dwordx4 v[52:55], v4, s[16:19], s66 offen offset:3072 nt
    buffer_load_dwordx4 v[68:71], v4, s[16:19], s67 offen offset:3072 nt
    s_waitcnt vmcnt(16)
    s_cmp_ge_u32 s60, 4
    s_cbranch_scc1 a_nc
    s_cmp_lt_u32 s60, 4
    s_cbranch_scc1 a_nc
    s_mov_b64 exec, 1
    v_mov_b32 v162, 1
    buffer_atomic_add v162, v5, s[56:59], s75 offen sc0 sc1
    s_mov_b64 exec, -1
a_nc:
    v_mfma_f32_16x16x32_bf16 v[136:139], v[72:75], v[152:155], 0
    v_mfma_f32_16x16x32_bf16 v[140:143], v[72:75], v[156:159], 0
    v_mfma_f32_16x16x32_bf16 v[144:147], v[88:91], v[152:155], 0
    v_mfma_f32_16x16x32_bf16 v[148:151], v[88:91], v[156:159], 0
    s_nop 5
    v_add_f32 v6, v136, v142
    v_add_f32 v7, v137, v143
    v_add_f32_dpp v6, v145, v151 quad_perm:[0,1,2,3] row_mask:0xf bank_mask:0xc
    v_add_f32_dpp v7, v144, v150 quad_perm:[0,1,2,3] row_mask:0xf bank_mask:0x3
    s_nop 1
    v_add_f32_dpp v12, v7, v6 row_ror:8 row_mask:0xf bank_mask:0xf
    buffer_load_dwordx4 v[72:75], v4, s[16:19], s68 offen offset:0 nt
    buffer_load_dwordx4 v[88:91], v4, s[16:19], s69 offen offset:0 nt
    v_mfma_f32_16x16x32_bf16 v[136:139], v[76:79], v[152:155], 0
    v_mfma_f32_16x16x32_bf16 v[140:143], v[76:79], v[156:159], 0
    v_mfma_f32_16x16x32_bf16 v[144:147], v[92:95], v[152:155], 0
    v_mfma_f32_16x16x32_bf16 v[148:151], v[92:95], v[156:159], 0
    s_nop 5
    v_add_f32 v6, v136, v142
    v_add_f32 v7, v137, v143
    v_add_f32_dpp v6, v145, v151 quad_perm:[0,1,2,3] row_mask:0xf bank_mask:0xc
    v_add_f32_dpp v7, v144, v150 quad_perm:[0,1,2,3] row_mask:0xf bank_mask:0x3
    s_nop 1
    v_add_f32_dpp v13, v7, v6 row_ror:8 row_mask:0xf bank_mask:0xf
    buffer_load_dwordx4 v[76:79], v4, s[16:19], s68 offen offset:1024 nt
    buffer_load_dwordx4 v[92:95], v4, s[16:19], s69 offen offset:1024 nt
    v_mfma_f32_16x16x32_bf16 v[136:139], v[80:83], v[152:155], 0
    v_mfma_f32_16x16x32_bf16 v[140:143], v[80:83], v[156:159], 0
    v_mfma_f32_16x16x32_bf16 v[144:147], v[96:99], v[152:155], 0
    v_mfma_f32_16x16x32_bf16 v[148:151], v[96:99], v[156:159], 0
    s_nop 5
    v_add_f32 v6, v136, v142
    v_add_f32 v7, v137, v143
    v_add_f32_dpp v6, v145, v151 quad_perm:[0,1,2,3] row_mask:0xf bank_mask:0xc
    v_add_f32_dpp v7, v144, v150 quad_perm:[0,1,2,3] row_mask:0xf bank_mask:0x3
    s_nop 1
    v_add_f32_dpp v14, v7, v6 row_ror:8 row_mask:0xf bank_mask:0xf
    buffer_load_dwordx4 v[80:83], v4, s[16:19], s68 offen offset:2048 nt
    buffer_load_dwordx4 v[96:99], v4, s[16:19], s69 offen offset:2048 nt
    v_mfma_f32_16x16x32_bf16 v[136:139], v[84:87], v[152:155], 0
    v_mfma_f32_16x16x32_bf16 v[140:143], v[84:87], v[156:159], 0
    v_mfma_f32_16x16x32_bf16 v[144:147], v[100:103], v[152:155], 0
    v_mfma_f32_16x16x32_bf16 v[148:151], v[100:103], v[156:159], 0
    s_nop 5
    v_add_f32 v6, v136, v142
    v_add_f32 v7, v137, v143
    v_add_f32_dpp v6, v145, v151 quad_perm:[0,1,2,3] row_mask:0xf bank_mask:0xc
    v_add_f32_dpp v7, v144, v150 quad_perm:[0,1,2,3] row_mask:0xf bank_mask:0x3
    s_nop 1
    v_add_f32_dpp v15, v7, v6 row_ror:8 row_mask:0xf bank_mask:0xf
    buffer_load_dwordx4 v[84:87], v4, s[16:19], s68 offen offset:3072 nt
    buffer_load_dwordx4 v[100:103], v4, s[16:19], s69 offen offset:3072 nt
    v_max3_f32 v6, v164, v165, v166
    v_max3_f32 v7, v167, v8, v9
    v_max3_f32 v6, v6, v10, v11
    v_max3_f32 v7, v7, v12, v13
    v_max3_f32 v6, v6, v14, v15
    v_max_f32 v6, v6, v7
    s_nop 1
    v_max_f32_dpp v6, v6, v6 row_ror:8 row_mask:0xf bank_mask:0xf
    v_mov_b32 v7, v6
    s_nop 1
    v_permlane16_swap_b32 v6, v7
    v_max_f32 v6, v6, v7
    v_mov_b32 v7, v6
    s_nop 1
    v_permlane32_swap_b32 v6, v7
    v_max_f32 v6, v6, v7
    v_mul_f32 v160, s78, v6
    v_fma_f32 v164, v164, s78, -v160
    v_fma_f32 v165, v165, s78, -v160
    v_fma_f32 v166, v166, s78, -v160
    v_fma_f32 v167, v167, s78, -v160
    v_fma_f32 v8, v8, s78, -v160
    v_fma_f32 v9, v9, s78, -v160
    v_fma_f32 v10, v10, s78, -v160
    v_fma_f32 v11, v11, s78, -v160
    v_fma_f32 v12, v12, s78, -v160
    v_fma_f32 v13, v13, s78, -v160
    v_fma_f32 v14, v14, s78, -v160
    v_fma_f32 v15, v15, s78, -v160
    v_exp_f32 v164, v164
    v_exp_f32 v165, v165
    v_exp_f32 v166, v166
    v_exp_f32 v167, v167
    v_exp_f32 v8, v8
    v_exp_f32 v9, v9
    v_exp_f32 v10, v10
    v_exp_f32 v11, v11
    v_exp_f32 v12, v12
    v_exp_f32 v13, v13
    v_exp_f32 v14, v14
    v_exp_f32 v15, v15
    v_add_f32 v6, v164, v165
    v_add_f32 v161, v166, v167
    v_add_f32 v6, v6, v8
    v_add_f32 v161, v161, v9
    v_add_f32 v6, v6, v10
    v_add_f32 v161, v161, v11
    v_add_f32 v6, v6, v12
    v_add_f32 v161, v161, v13
    v_add_f32 v6, v6, v14
    v_add_f32 v161, v161, v15
    v_add_f32 v161, v6, v161
    v_cvt_pk_bf16_f32 v0, v8, v9
    v_cvt_pk_bf16_f32 v1, v10, v11
    v_cvt_pk_bf16_f32 v2, v12, v13
    v_cvt_pk_bf16_f32 v163, v14, v15
    v_cvt_pk_bf16_f32 v164, v164, v165
    v_cvt_pk_bf16_f32 v165, v166, v167
    s_nop 0
    v_mov_b32_dpp v166, v164 row_ror:8 row_mask:0xf bank_mask:0xf
    v_mov_b32_dpp v167, v165 row_ror:8 row_mask:0xf bank_mask:0xf
    s_waitcnt vmcnt(16)
    v_perm_b32 v136, v108, v104, s76
    v_perm_b32 v137, v116, v112, s76
    v_perm_b32 v138, v124, v120, s76
    v_perm_b32 v139, v132, v128, s76
    v_perm_b32 v140, v108, v104, s77
    v_perm_b32 v141, v116, v112, s77
    v_perm_b32 v142, v124, v120, s77
    v_perm_b32 v143, v132, v128, s77
    v_perm_b32 v144, v109, v105, s76
    v_perm_b32 v145, v117, v113, s76
    v_perm_b32 v146, v125, v121, s76
    v_perm_b32 v147, v133, v129, s76
    v_perm_b32 v148, v109, v105, s77
    v_perm_b32 v149, v117, v113, s77
    v_perm_b32 v150, v125, v121, s77
    v_perm_b32 v151, v133, v129, s77
    v_mfma_f32_16x16x32_bf16 v[8:11], v[136:139], v[164:167], 0
    v_mfma_f32_16x16x32_bf16 v[12:15], v[140:143], v[164:167], 0
    v_perm_b32 v136, v110, v106, s76
    v_perm_b32 v137, v118, v114, s76
    v_perm_b32 v138, v126, v122, s76
    v_perm_b32 v139, v134, v130, s76
    v_perm_b32 v140, v110, v106, s77
    v_perm_b32 v141, v118, v114, s77
    v_perm_b32 v142, v126, v122, s77
    v_perm_b32 v143, v134, v130, s77
    v_mfma_f32_16x16x32_bf16 v[16:19], v[144:147], v[164:167], 0
    v_mfma_f32_16x16x32_bf16 v[20:23], v[148:151], v[164:167], 0
    v_perm_b32 v144, v111, v107, s76
    v_perm_b32 v145, v119, v115, s76
    v_perm_b32 v146, v127, v123, s76
    v_perm_b32 v147, v135, v131, s76
    v_perm_b32 v148, v111, v107, s77
    v_perm_b32 v149, v119, v115, s77
    v_perm_b32 v150, v127, v123, s77
    v_perm_b32 v151, v135, v131, s77
    v_mfma_f32_16x16x32_bf16 v[24:27], v[136:139], v[164:167], 0
    v_mfma_f32_16x16x32_bf16 v[28:31], v[140:143], v[164:167], 0
    v_mfma_f32_16x16x32_bf16 v[32:35], v[144:147], v[164:167], 0
    v_mfma_f32_16x16x32_bf16 v[36:39], v[148:151], v[164:167], 0
    v_mov_b32 v164, v0
    v_mov_b32 v165, v1
    v_mov_b32_dpp v166, v0 row_ror:8 row_mask:0xf bank_mask:0xf
    v_mov_b32_dpp v167, v1 row_ror:8 row_mask:0xf bank_mask:0xf
    s_waitcnt vmcnt(8)
    s_setprio 0
    v_readfirstlane_b32 s99, v162
    s_cmp_lt_u32 s99, 128
    s_cbranch_scc0 a_n0
    s_mul_i32 s70, s99, 32768
    s_add_u32 s70, s70, s97
    s_add_u32 s71, s70, 4096
    buffer_load_dwordx4 v[104:107], v3, s[12:15], s70 offen offset:0 nt
    buffer_load_dwordx4 v[108:111], v3, s[12:15], s70 offen offset:1024 nt
    buffer_load_dwordx4 v[112:115], v3, s[12:15], s70 offen offset:2048 nt
    buffer_load_dwordx4 v[116:119], v3, s[12:15], s70 offen offset:3072 nt
    buffer_load_dwordx4 v[120:123], v3, s[12:15], s71 offen offset:0 nt
    buffer_load_dwordx4 v[124:127], v3, s[12:15], s71 offen offset:1024 nt
    buffer_load_dwordx4 v[128:131], v3, s[12:15], s71 offen offset:2048 nt
    buffer_load_dwordx4 v[132:135], v3, s[12:15], s71 offen offset:3072 nt
    s_mov_b64 exec, 1
    v_mov_b32 v162, 1
    buffer_atomic_add v162, v5, s[56:59], s75 offen sc0 sc1
    s_mov_b64 exec, -1
a_n0:
    v_perm_b32 v136, v44, v40, s76
    v_perm_b32 v137, v52, v48, s76
    v_perm_b32 v138, v60, v56, s76
    v_perm_b32 v139, v68, v64, s76
    v_perm_b32 v140, v44, v40, s77
    v_perm_b32 v141, v52, v48, s77
    v_perm_b32 v142, v60, v56, s77
    v_perm_b32 v143, v68, v64, s77
    v_perm_b32 v144, v45, v41, s76
    v_perm_b32 v145, v53, v49, s76
    v_perm_b32 v146, v61, v57, s76
    v_perm_b32 v147, v69, v65, s76
    v_perm_b32 v148, v45, v41, s77
    v_perm_b32 v149, v53, v49, s77
    v_perm_b32 v150, v61, v57, s77
    v_perm_b32 v151, v69, v65, s77
    v_mfma_f32_16x16x32_bf16 v[8:11], v[136:139], v[164:167], v[8:11]
    v_mfma_f32_16x16x32_bf16 v[12:15], v[140:143], v[164:167], v[12:15]
    v_perm_b32 v136, v46, v42, s76
    v_perm_b32 v137, v54, v50, s76
    v_perm_b32 v138, v62, v58, s76
    v_perm_b32 v139, v70, v66, s76
    v_perm_b32 v140, v46, v42, s77
    v_perm_b32 v141, v54, v50, s77
    v_perm_b32 v142, v62, v58, s77
    v_perm_b32 v143, v70, v66, s77
    v_mfma_f32_16x16x32_bf16 v[16:19], v[144:147], v[164:167], v[16:19]
    v_mfma_f32_16x16x32_bf16 v[20:23], v[148:151], v[164:167], v[20:23]
    v_perm_b32 v144, v47, v43, s76
    v_perm_b32 v145, v55, v51, s76
    v_perm_b32 v146, v63, v59, s76
    v_perm_b32 v147, v71, v67, s76
    v_perm_b32 v148, v47, v43, s77
    v_perm_b32 v149, v55, v51, s77
    v_perm_b32 v150, v63, v59, s77
    v_perm_b32 v151, v71, v67, s77
    v_mfma_f32_16x16x32_bf16 v[24:27], v[136:139], v[164:167], v[24:27]
    v_mfma_f32_16x16x32_bf16 v[28:31], v[140:143], v[164:167], v[28:31]
    v_mfma_f32_16x16x32_bf16 v[32:35], v[144:147], v[164:167], v[32:35]
    v_mfma_f32_16x16x32_bf16 v[36:39], v[148:151], v[164:167], v[36:39]
    v_mov_b32 v164, v2
    v_mov_b32 v165, v163
    v_mov_b32_dpp v166, v2 row_ror:8 row_mask:0xf bank_mask:0xf
    v_mov_b32_dpp v167, v163 row_ror:8 row_mask:0xf bank_mask:0xf
    v_lshrrev_b32 v1, 4, v4
    v_lshrrev_b32 v2, 4, v1
    s_mul_i32 s62, s60, 4224
    v_and_b32 v6, 15, v1
    v_mul_u32_u24 v40, 528, v6
    v_lshl_add_u32 v40, v2, 7, v40
    v_add_u32 v40, s62, v40
    s_mul_i32 s62, s60, 528
    v_add_u32 v41, s62, v4
    s_lshl_b32 s62, s60, 2
    s_add_u32 s62, s62, 3584
    v_lshl_add_u32 v48, v1, 5, s62
    s_lshl_b32 s62, s60, 5
    v_mov_b32 v49, s62
    v_lshrrev_b32 v42, 2, v1
    v_lshlrev_b32 v42, 13, v42
    v_and_b32 v43, 3, v1
    v_lshl_add_u32 v42, v43, 4, v42
    v_and_b32 v43, 7, v1
    v_lshlrev_b32 v43, 13, v43
    v_add_u32 v43, 64, v43
    v_cmp_gt_u32 vcc, 32, v1
    s_nop 1
    v_cndmask_b32 v42, v43, v42, vcc
    s_lshl_b32 s73, s73, 3
    s_add_u32 s62, s73, s60
    s_lshl_b32 s62, s62, 16
    s_lshl_b32 s72, s63, 7
    s_add_u32 s62, s62, s72
    s_add_u32 s62, s62, 0x400000
    s_branch a_mid
a_loop:
    s_sub_u32 s91, s91, 0x200
    s_cbranch_scc1 k_end
    s_waitcnt vmcnt(8)
    v_mfma_f32_16x16x32_bf16 v[136:139], v[104:107], v[152:155], 0
    v_mfma_f32_16x16x32_bf16 v[140:143], v[104:107], v[156:159], 0
    v_mfma_f32_16x16x32_bf16 v[144:147], v[120:123], v[152:155], 0
    v_mfma_f32_16x16x32_bf16 v[148:151], v[120:123], v[156:159], 0
    s_nop 5
    v_add_f32 v6, v136, v142
    v_add_f32 v7, v137, v143
    v_add_f32_dpp v6, v145, v151 quad_perm:[0,1,2,3] row_mask:0xf bank_mask:0xc
    v_add_f32_dpp v7, v144, v150 quad_perm:[0,1,2,3] row_mask:0xf bank_mask:0x3
    s_nop 1
    v_add_f32_dpp v164, v7, v6 row_ror:8 row_mask:0xf bank_mask:0xf
    v_mfma_f32_16x16x32_bf16 v[136:139], v[108:111], v[152:155], 0
    v_mfma_f32_16x16x32_bf16 v[140:143], v[108:111], v[156:159], 0
    v_mfma_f32_16x16x32_bf16 v[144:147], v[124:127], v[152:155], 0
    v_mfma_f32_16x16x32_bf16 v[148:151], v[124:127], v[156:159], 0
    s_nop 5
    v_add_f32 v6, v136, v142
    v_add_f32 v7, v137, v143
    v_add_f32_dpp v6, v145, v151 quad_perm:[0,1,2,3] row_mask:0xf bank_mask:0xc
    v_add_f32_dpp v7, v144, v150 quad_perm:[0,1,2,3] row_mask:0xf bank_mask:0x3
    s_nop 1
    v_add_f32_dpp v165, v7, v6 row_ror:8 row_mask:0xf bank_mask:0xf
    v_mfma_f32_16x16x32_bf16 v[136:139], v[112:115], v[152:155], 0
    v_mfma_f32_16x16x32_bf16 v[140:143], v[112:115], v[156:159], 0
    v_mfma_f32_16x16x32_bf16 v[144:147], v[128:131], v[152:155], 0
    v_mfma_f32_16x16x32_bf16 v[148:151], v[128:131], v[156:159], 0
    s_nop 5
    v_add_f32 v6, v136, v142
    v_add_f32 v7, v137, v143
    v_add_f32_dpp v6, v145, v151 quad_perm:[0,1,2,3] row_mask:0xf bank_mask:0xc
    v_add_f32_dpp v7, v144, v150 quad_perm:[0,1,2,3] row_mask:0xf bank_mask:0x3
    s_nop 1
    v_add_f32_dpp v166, v7, v6 row_ror:8 row_mask:0xf bank_mask:0xf
    v_mfma_f32_16x16x32_bf16 v[136:139], v[116:119], v[152:155], 0
    v_mfma_f32_16x16x32_bf16 v[140:143], v[116:119], v[156:159], 0
    v_mfma_f32_16x16x32_bf16 v[144:147], v[132:135], v[152:155], 0
    v_mfma_f32_16x16x32_bf16 v[148:151], v[132:135], v[156:159], 0
    s_nop 5
    v_add_f32 v6, v136, v142
    v_add_f32 v7, v137, v143
    v_add_f32_dpp v6, v145, v151 quad_perm:[0,1,2,3] row_mask:0xf bank_mask:0xc
    v_add_f32_dpp v7, v144, v150 quad_perm:[0,1,2,3] row_mask:0xf bank_mask:0x3
    s_nop 1
    v_add_f32_dpp v167, v7, v6 row_ror:8 row_mask:0xf bank_mask:0xf
    v_readfirstlane_b32 s99, v162
    s_cmp_lt_u32 s99, 128
    s_cbranch_scc0 a_n1
    s_mul_i32 s70, s99, 32768
    s_add_u32 s70, s70, s97
    s_add_u32 s71, s70, 4096
    buffer_load_dwordx4 v[104:107], v3, s[12:15], s70 offen offset:0 nt
    buffer_load_dwordx4 v[108:111], v3, s[12:15], s70 offen offset:1024 nt
    buffer_load_dwordx4 v[112:115], v3, s[12:15], s70 offen offset:2048 nt
    buffer_load_dwordx4 v[116:119], v3, s[12:15], s70 offen offset:3072 nt
    buffer_load_dwordx4 v[120:123], v3, s[12:15], s71 offen offset:0 nt
    buffer_load_dwordx4 v[124:127], v3, s[12:15], s71 offen offset:1024 nt
    buffer_load_dwordx4 v[128:131], v3, s[12:15], s71 offen offset:2048 nt
    buffer_load_dwordx4 v[132:135], v3, s[12:15], s71 offen offset:3072 nt
    s_mov_b64 exec, 1
    v_mov_b32 v162, 1
    buffer_atomic_add v162, v5, s[56:59], s75 offen sc0 sc1
    s_mov_b64 exec, -1
a_n1:
    v_max3_f32 v6, v164, v165, v166
    v_max_f32 v6, v6, v167
    s_nop 1
    v_max_f32_dpp v6, v6, v6 row_ror:8 row_mask:0xf bank_mask:0xf
    v_mov_b32 v7, v6
    s_nop 1
    v_permlane16_swap_b32 v6, v7
    v_max_f32 v6, v6, v7
    v_mov_b32 v7, v6
    s_nop 1
    v_permlane32_swap_b32 v6, v7
    v_max_f32 v6, v6, v7
    v_mul_f32 v6, s78, v6
    v_max_f32 v6, v6, v160
    v_sub_f32 v0, v160, v6
    v_mov_b32 v160, v6
    v_exp_f32 v0, v0
    v_fma_f32 v164, v164, s78, -v6
    v_fma_f32 v165, v165, s78, -v6
    v_fma_f32 v166, v166, s78, -v6
    v_fma_f32 v167, v167, s78, -v6
    v_exp_f32 v164, v164
    v_exp_f32 v165, v165
    v_exp_f32 v166, v166
    v_exp_f32 v167, v167
    v_add_f32 v6, v164, v165
    v_add_f32 v7, v166, v167
    v_fma_f32 v161, v161, v0, v6
    v_add_f32 v161, v161, v7
    v_cvt_pk_bf16_f32 v164, v164, v165
    v_cvt_pk_bf16_f32 v165, v166, v167
    s_nop 0
    v_mov_b32_dpp v166, v164 row_ror:8 row_mask:0xf bank_mask:0xf
    v_mov_b32_dpp v167, v165 row_ror:8 row_mask:0xf bank_mask:0xf
    v_mul_f32 v8, v8, v0
    v_mul_f32 v9, v9, v0
    v_mul_f32 v10, v10, v0
    v_mul_f32 v11, v11, v0
    v_mul_f32 v12, v12, v0
    v_mul_f32 v13, v13, v0
    v_mul_f32 v14, v14, v0
    v_mul_f32 v15, v15, v0
    v_mul_f32 v16, v16, v0
    v_mul_f32 v17, v17, v0
    v_mul_f32 v18, v18, v0
    v_mul_f32 v19, v19, v0
    v_mul_f32 v20, v20, v0
    v_mul_f32 v21, v21, v0
    v_mul_f32 v22, v22, v0
    v_mul_f32 v23, v23, v0
    v_mul_f32 v24, v24, v0
    v_mul_f32 v25, v25, v0
    v_mul_f32 v26, v26, v0
    v_mul_f32 v27, v27, v0
    v_mul_f32 v28, v28, v0
    v_mul_f32 v29, v29, v0
    v_mul_f32 v30, v30, v0
    v_mul_f32 v31, v31, v0
    v_mul_f32 v32, v32, v0
    v_mul_f32 v33, v33, v0
    v_mul_f32 v34, v34, v0
    v_mul_f32 v35, v35, v0
    v_mul_f32 v36, v36, v0
    v_mul_f32 v37, v37, v0
    v_mul_f32 v38, v38, v0
    v_mul_f32 v39, v39, v0
a_mid:
    s_nop 1
    s_waitcnt vmcnt(9)
    s_cmp_lt_u32 s99, 128
    s_cbranch_scc1 a_w
    s_waitcnt vmcnt(0)
a_w:
    v_perm_b32 v136, v76, v72, s76
    v_perm_b32 v137, v84, v80, s76
    v_perm_b32 v138, v92, v88, s76
    v_perm_b32 v139, v100, v96, s76
    v_perm_b32 v140, v76, v72, s77
    v_perm_b32 v141, v84, v80, s77
    v_perm_b32 v142, v92, v88, s77
    v_perm_b32 v143, v100, v96, s77
    v_perm_b32 v144, v77, v73, s76
    v_perm_b32 v145, v85, v81, s76
    v_perm_b32 v146, v93, v89, s76
    v_perm_b32 v147, v101, v97, s76
    v_perm_b32 v148, v77, v73, s77
    v_perm_b32 v149, v85, v81, s77
    v_perm_b32 v150, v93, v89, s77
    v_perm_b32 v151, v101, v97, s77
    v_mfma_f32_16x16x32_bf16 v[8:11], v[136:139], v[164:167], v[8:11]
    v_mfma_f32_16x16x32_bf16 v[12:15], v[140:143], v[164:167], v[12:15]
    v_perm_b32 v136, v78, v74, s76
    v_perm_b32 v137, v86, v82, s76
    v_perm_b32 v138, v94, v90, s76
    v_perm_b32 v139, v102, v98, s76
    v_perm_b32 v140, v78, v74, s77
    v_perm_b32 v141, v86, v82, s77
    v_perm_b32 v142, v94, v90, s77
    v_perm_b32 v143, v102, v98, s77
    v_mfma_f32_16x16x32_bf16 v[16:19], v[144:147], v[164:167], v[16:19]
    v_mfma_f32_16x16x32_bf16 v[20:23], v[148:151], v[164:167], v[20:23]
    v_perm_b32 v144, v79, v75, s76
    v_perm_b32 v145, v87, v83, s76
    v_perm_b32 v146, v95, v91, s76
    v_perm_b32 v147, v103, v99, s76
    v_perm_b32 v148, v79, v75, s77
    v_perm_b32 v149, v87, v83, s77
    v_perm_b32 v150, v95, v91, s77
    v_perm_b32 v151, v103, v99, s77
    v_mfma_f32_16x16x32_bf16 v[24:27], v[136:139], v[164:167], v[24:27]
    v_mfma_f32_16x16x32_bf16 v[28:31], v[140:143], v[164:167], v[28:31]
    v_mfma_f32_16x16x32_bf16 v[32:35], v[144:147], v[164:167], v[32:35]
    v_mfma_f32_16x16x32_bf16 v[36:39], v[148:151], v[164:167], v[36:39]
    s_cbranch_scc0 a_tail0
a_vn:
    buffer_load_dwordx4 v[72:75], v4, s[16:19], s70 offen offset:0 nt
    buffer_load_dwordx4 v[76:79], v4, s[16:19], s70 offen offset:1024 nt
    buffer_load_dwordx4 v[80:83], v4, s[16:19], s70 offen offset:2048 nt
    buffer_load_dwordx4 v[84:87], v4, s[16:19], s70 offen offset:3072 nt
    buffer_load_dwordx4 v[88:91], v4, s[16:19], s71 offen offset:0 nt
    buffer_load_dwordx4 v[92:95], v4, s[16:19], s71 offen offset:1024 nt
    buffer_load_dwordx4 v[96:99], v4, s[16:19], s71 offen offset:2048 nt
    buffer_load_dwordx4 v[100:103], v4, s[16:19], s71 offen offset:3072 nt
    s_branch a_loop
a_tail0:
    s_cmp_ge_u32 s98, 4
    s_cbranch_scc1 a_tail
    s_mov_b32 s98, 8
a_sv2:
    ds_read_b32 v6, v5 offset:20
    s_waitcnt lgkmcnt(0)
    v_readfirstlane_b32 s92, v6
    s_cmp_ge_u32 s92, 1
    s_cbranch_scc1 a_sv2_d
    s_sub_u32 s90, s90, 1
    s_cbranch_scc0 a_sv2
    s_endpgm
a_sv2_d:
a_sk2:
    s_cmp_ge_u32 s92, 5
    s_cbranch_scc1 a_tail
    s_mov_b64 exec, 1
    v_mov_b32 v162, 1
    buffer_atomic_add v162, v5, s[56:59], s75 offen sc0 sc1
    s_mov_b64 exec, -1
    s_waitcnt vmcnt(0)
    v_readfirstlane_b32 s99, v162
    s_cmp_lt_u32 s99, 128
    s_cbranch_scc0 a_n2
    s_mul_i32 s70, s99, 32768
    s_add_u32 s70, s70, s97
    s_add_u32 s71, s70, 4096
    buffer_load_dwordx4 v[104:107], v3, s[12:15], s70 offen offset:0 nt
    buffer_load_dwordx4 v[108:111], v3, s[12:15], s70 offen offset:1024 nt
    buffer_load_dwordx4 v[112:115], v3, s[12:15], s70 offen offset:2048 nt
    buffer_load_dwordx4 v[116:119], v3, s[12:15], s70 offen offset:3072 nt
    buffer_load_dwordx4 v[120:123], v3, s[12:15], s71 offen offset:0 nt
    buffer_load_dwordx4 v[124:127], v3, s[12:15], s71 offen offset:1024 nt
    buffer_load_dwordx4 v[128:131], v3, s[12:15], s71 offen offset:2048 nt
    buffer_load_dwordx4 v[132:135], v3, s[12:15], s71 offen offset:3072 nt
    s_mov_b64 exec, 1
    v_mov_b32 v162, 1
    buffer_atomic_add v162, v5, s[56:59], s75 offen sc0 sc1
    s_mov_b64 exec, -1
a_n2:
    s_cmp_lt_u32 s99, 128
    s_cbranch_scc1 a_vn
a_tail:
    v_add_f32_dpp v161, v161, v161 row_ror:8 row_mask:0xf bank_mask:0xf
    v_mov_b32 v6, v161
    s_nop 1
    v_permlane16_swap_b32 v161, v6
    v_add_f32 v161, v161, v6
    v_mov_b32 v6, v161
    s_nop 1
    v_permlane32_swap_b32 v161, v6
    v_add_f32 v161, v161, v6
    v_mov_b32 v7, 1
    s_mov_b32 exec_lo, 0x00ff00ff
    s_mov_b32 exec_hi, 0x00ff00ff
    ds_write_b128 v40, v[8:11] offset:4096
    ds_write_b128 v40, v[12:15] offset:4112
    ds_write_b128 v40, v[16:19] offset:4128
    ds_write_b128 v40, v[20:23] offset:4144
    ds_write_b128 v40, v[24:27] offset:4160
    ds_write_b128 v40, v[28:31] offset:4176
    ds_write_b128 v40, v[32:35] offset:4192
    ds_write_b128 v40, v[36:39] offset:4208
    s_mov_b64 exec, 0xff
    ds_write2_b32 v48, v160, v161 offset0:0 offset1:64
    s_mov_b64 exec, 1
    ds_add_u32 v5, v7 offset:20
    s_mov_b64 exec, -1
a_so:
    ds_read_b32 v6, v5 offset:20
    s_waitcnt lgkmcnt(0)
    v_readfirstlane_b32 s92, v6
    s_cmp_ge_u32 s92, 8
    s_cbranch_scc1 a_so_d
    s_sub_u32 s90, s90, 1
    s_cbranch_scc0 a_so
    s_endpgm
a_so_d:
    ds_read_b128 v[72:75], v49 offset:3584
    ds_read_b128 v[76:79], v49 offset:3600
    ds_read_b128 v[80:83], v49 offset:3840
    ds_read_b128 v[84:87], v49 offset:3856
    s_mov_b32 exec_hi, 0
    ds_read_b128 v[8:11], v41 offset:4096
    ds_read_b128 v[12:15], v41 offset:8320
    ds_read_b128 v[16:19], v41 offset:12544
    ds_read_b128 v[20:23], v41 offset:16768
    ds_read_b128 v[24:27], v41 offset:20992
    ds_read_b128 v[28:31], v41 offset:25216
    ds_read_b128 v[32:35], v41 offset:29440
    ds_read_b128 v[36:39], v41 offset:33664
    s_mov_b32 exec_hi, 0xff
    s_waitcnt lgkmcnt(10)
    v_max3_f32 v6, v72, v73, v74
    v_max3_f32 v6, v6, v75, v76
    v_max3_f32 v6, v6, v77, v78
    v_max_f32 v6, v6, v79
    v_sub_f32 v72, v72, v6
    v_sub_f32 v73, v73, v6
    v_sub_f32 v74, v74, v6
    v_sub_f32 v75, v75, v6
    v_sub_f32 v76, v76, v6
    v_sub_f32 v77, v77, v6
    v_sub_f32 v78, v78, v6
    v_sub_f32 v79, v79, v6
    v_exp_f32 v72, v72
    v_exp_f32 v73, v73
    v_exp_f32 v74, v74
    v_exp_f32 v75, v75
    v_exp_f32 v76, v76
    v_exp_f32 v77, v77
    v_exp_f32 v78, v78
    v_exp_f32 v79, v79
    s_waitcnt lgkmcnt(8)
    v_mul_f32 v7, v72, v80
    v_mul_f32 v80, v73, v81
    v_fmac_f32 v7, v74, v82
    v_fmac_f32 v80, v75, v83
    v_fmac_f32 v7, v76, v84
    v_fmac_f32 v80, v77, v85
    v_fmac_f32 v7, v78, v86
    v_fmac_f32 v80, v79, v87
    v_add_f32 v7, v7, v80
    s_mov_b32 exec_hi, 0
    s_waitcnt lgkmcnt(6)
    v_mul_f32 v8, v8, v72
    v_mul_f32 v12, v12, v73
    v_mul_f32 v9, v9, v72
    v_mul_f32 v13, v13, v73
    v_mul_f32 v10, v10, v72
    v_mul_f32 v14, v14, v73
    v_mul_f32 v11, v11, v72
    v_mul_f32 v15, v15, v73
    s_waitcnt lgkmcnt(4)
    v_fmac_f32 v8, v16, v74
    v_fmac_f32 v12, v20, v75
    v_fmac_f32 v9, v17, v74
    v_fmac_f32 v13, v21, v75
    v_fmac_f32 v10, v18, v74
    v_fmac_f32 v14, v22, v75
    v_fmac_f32 v11, v19, v74
    v_fmac_f32 v15, v23, v75
    s_waitcnt lgkmcnt(2)
    v_fmac_f32 v8, v24, v76
    v_fmac_f32 v12, v28, v77
    v_fmac_f32 v9, v25, v76
    v_fmac_f32 v13, v29, v77
    v_fmac_f32 v10, v26, v76
    v_fmac_f32 v14, v30, v77
    v_fmac_f32 v11, v27, v76
    v_fmac_f32 v15, v31, v77
    s_waitcnt lgkmcnt(0)
    v_fmac_f32 v8, v32, v78
    v_fmac_f32 v12, v36, v79
    v_fmac_f32 v9, v33, v78
    v_fmac_f32 v13, v37, v79
    v_fmac_f32 v10, v34, v78
    v_fmac_f32 v14, v38, v79
    v_fmac_f32 v11, v35, v78
    v_fmac_f32 v15, v39, v79
    v_add_f32 v8, v8, v12
    v_add_f32 v9, v9, v13
    v_add_f32 v10, v10, v14
    v_add_f32 v11, v11, v15
    s_mov_b32 exec_lo, 0
    s_mov_b32 exec_hi, 0xff
    v_mov_b32 v8, v6
    v_mov_b32 v9, v7
    v_mov_b32 v10, 0
    v_mov_b32 v11, 0
    s_mov_b32 exec_lo, -1
    v_min_u32 v8, -2, v8
    v_min_u32 v9, -2, v9
    v_min_u32 v10, -2, v10
    v_min_u32 v11, -2, v11
    buffer_store_dwordx4 v[8:11], v42, s[56:59], s62 offen sc1
    s_mov_b64 exec, -1
    v_mov_b32 v0, v1
    v_mov_b32 v7, 1
    s_cmp_lt_u32 s63, 56
    s_cbranch_scc1 a_fin
    s_mov_b64 exec, -1
    s_and_b32 s63, s63, 7
    s_add_u32 s73, s73, s63
    s_lshl_b32 s62, s73, 15
    s_lshl_b32 s72, s60, 12
    s_add_u32 s62, s62, s72
    s_add_u32 s62, s62, 0x40000
    s_lshl_b32 s73, s73, 6
    v_and_b32 v6, 7, v0
    v_lshl_add_u32 v6, v2, 3, v6
    s_lshl_b32 s72, s60, 7
    v_lshl_add_u32 v44, v6, 2, s72
    v_lshlrev_b32 v45, 2, v0
    v_lshlrev_b32 v46, 1, v0
    s_mov_b32 s72, 0
    v_mov_b32 v47, 44
    s_branch a_red
a_real:
    s_mov_b32 s72, 1
    s_mov_b64 exec, -1
    v_mov_b32 v47, 40
a_sz:
    ds_read_b32 v6, v5 offset:36
    s_waitcnt lgkmcnt(0)
    v_readfirstlane_b32 s92, v6
    s_cmp_ge_u32 s92, 4
    s_cbranch_scc1 a_sz_d
    s_sub_u32 s90, s90, 1
    s_cbranch_scc0 a_sz
    s_endpgm
a_sz_d:
a_pz:
    buffer_load_dwordx4 v[16:19], v4, s[56:59], s62 offen offset:0 sc1
    buffer_load_dwordx4 v[20:23], v4, s[56:59], s62 offen offset:1024 sc1
    buffer_load_dwordx4 v[24:27], v4, s[56:59], s62 offen offset:2048 sc1
    buffer_load_dwordx4 v[28:31], v4, s[56:59], s62 offen offset:3072 sc1
    s_waitcnt vmcnt(0)
    v_max3_u32 v6, v16, v17, v18
    v_max3_u32 v6, v6, v19, v20
    v_max3_u32 v6, v6, v21, v22
    v_max3_u32 v6, v6, v23, v24
    v_max3_u32 v6, v6, v25, v26
    v_max3_u32 v6, v6, v27, v28
    v_max3_u32 v6, v6, v29, v30
    v_max_u32 v6, v6, v31
    v_cmp_eq_u32 vcc, -1, v6
    s_cbranch_vccz a_pz_d
    s_mov_b64 exec, vcc
    s_sub_u32 s91, s91, 1
    s_cbranch_scc0 a_pz
    s_endpgm
a_pz_d:
    s_mov_b64 exec, -1
a_red:
    v_add_f32 v16, v16, v20
    v_add_f32 v24, v24, v28
    v_add_f32 v17, v17, v21
    v_add_f32 v25, v25, v29
    v_add_f32 v18, v18, v22
    v_add_f32 v26, v26, v30
    v_add_f32 v19, v19, v23
    v_add_f32 v27, v27, v31
    v_add_f32 v16, v16, v24
    v_add_f32 v17, v17, v25
    v_add_f32 v18, v18, v26
    v_add_f32 v19, v19, v27
    s_nop 0
    v_permlane32_swap_b32 v16, v18
    v_permlane32_swap_b32 v17, v19
    v_add_f32 v16, v16, v18
    v_add_f32 v17, v17, v19
    s_nop 1
    v_permlane16_swap_b32 v16, v17
    v_add_f32 v16, v16, v17
    s_nop 1
    v_add_f32_dpp v16, v16, v16 row_ror:8 row_mask:0xf bank_mask:0xf
    s_mov_b32 exec_lo, 0x00ff00ff
    s_mov_b32 exec_hi, 0x00ff00ff
    ds_write_b32 v44, v16 offset:37888
    s_mov_b64 exec, 1
    ds_add_rtn_u32 v6, v47, v7
    s_waitcnt lgkmcnt(0)
    v_readfirstlane_b32 s74, v6
    s_mov_b32 exec_lo, -1
    s_cmp_eq_u32 s72, 0
    s_cbranch_scc1 a_sum
    s_cmp_lg_u32 s74, 7
    s_cbranch_scc1 a_fin
a_sum:
    ds_read_b32 v16, v45 offset:37888
    ds_read_b32 v17, v45 offset:38016
    ds_read_b32 v18, v45 offset:38144
    ds_read_b32 v19, v45 offset:38272
    ds_read_b32 v20, v45 offset:38400
    ds_read_b32 v21, v45 offset:38528
    ds_read_b32 v22, v45 offset:38656
    ds_read_b32 v23, v45 offset:38784
    ds_read_b32 v24, v45 offset:38912
    s_waitcnt lgkmcnt(0)
    v_add_f32 v16, v16, v17
    v_add_f32 v18, v18, v19
    v_add_f32 v20, v20, v21
    v_add_f32 v22, v22, v23
    v_add_f32 v16, v16, v18
    v_add_f32 v20, v20, v22
    v_add_f32 v16, v16, v24
    v_add_f32 v16, v16, v20
    v_cvt_pk_bf16_f32 v16, v16, v16
    s_cmp_eq_u32 s72, 0
    s_cbranch_scc1 a_real
    buffer_store_short v16, v46, s[48:51], s73 offen
a_fin:
    s_endpgm
k_svc:
    s_load_dwordx2 s[8:9], s[0:1], 0
    s_load_dwordx2 s[20:21], s[0:1], 24
    s_load_dwordx2 s[52:53], s[0:1], 96
    s_load_dwordx2 s[32:33], s[0:1], 56
    s_load_dwordx2 s[36:37], s[0:1], 64
    s_load_dwordx2 s[44:45], s[0:1], 80
    s_load_dwordx2 s[28:29], s[0:1], 48
    s_load_dwordx2 s[40:41], s[0:1], 72
    s_load_dwordx2 s[24:25], s[0:1], 32
    s_setprio 3
    s_mov_b32 s10, 0x800
    s_mov_b32 s11, 0x00020000
    s_mov_b32 s22, 0x800000
    s_mov_b32 s23, 0x00020000
    s_mov_b32 s58, 0x10000000
    s_mov_b32 s59, 0x00020000
    s_mov_b32 s54, 0x100
    s_mov_b32 s55, 0x00020000
    s_mov_b32 s34, 0x700000
    s_mov_b32 s35, 0x00020000
    s_mov_b32 s38, 0x700000
    s_mov_b32 s39, 0x00020000
    s_mov_b32 s46, 0x800
    s_mov_b32 s47, 0x00020000
    s_mov_b32 s30, 0x800
    s_mov_b32 s31, 0x00020000
    s_mov_b32 s42, 0x700000
    s_mov_b32 s43, 0x00020000
    s_mov_b32 s26, 0x800000
    s_mov_b32 s27, 0x00020000
    v_and_b32 v1, 15, v0
    v_lshrrev_b32 v2, 4, v0
    s_mov_b32 s62, s60
    s_lshr_b32 s63, s61, 6
    s_and_b32 s64, s61, 63
    v_lshrrev_b32 v3, 3, v1
    v_lshlrev_b32 v3, 5, v3
    v_lshl_add_u32 v3, v2, 3, v3
    v_and_b32 v11, 7, v1
    v_lshlrev_b32 v11, 4, v11
    v_lshlrev_b32 v8, 4, v0
    v_mov_b32 v9, 0
    v_mov_b32 v10, 1
    s_lshl_b32 s69, s61, 12
    s_mul_i32 s3, s64, 4682
    s_lshr_b32 s3, s3, 16
    s_mul_i32 s4, s3, 14
    s_sub_u32 s4, s64, s4
    s_mul_i32 s5, s63, 28672
    s_mul_i32 s6, s3, 7168
    s_add_u32 s5, s5, s6
    s_lshl_b32 s6, s4, 8
    s_add_u32 s5, s5, s6
    s_add_u32 s5, s5, 0x10000
    s_lshl_b32 s6, s63, 6
    s_cmp_ge_u32 s62, 2
    s_cbranch_scc1 s_ctl
    s_lshr_b32 s65, s64, 4
    s_lshl_b32 s65, s65, 8
    s_lshl_b32 s66, s62, 7
    s_add_u32 s65, s65, s66
    v_add_u32 v4, s65, v3
    v_lshlrev_b32 v6, 1, v4
    s_lshl_b32 s66, s63, 11
    s_and_b32 s67, s64, 15
    s_lshl_b32 s67, s67, 7
    s_add_u32 s66, s66, s67
    v_lshlrev_b32 v4, 13, v4
    v_add3_u32 v4, v4, v11, s66
    v_add_u32 v5, 0x80000, v4
    s_mov_b32 s70, 8192
    s_mov_b32 s71, 16384
    s_mov_b32 s72, 24576
    s_mov_b32 s73, 32768
    s_mov_b32 s74, 40960
    s_mov_b32 s75, 49152
    s_mov_b32 s76, 57344
    s_waitcnt lgkmcnt(0)
    s_and_b32 s9, s9, 0xffff
    s_and_b32 s21, s21, 0xffff
    s_and_b32 s57, s57, 0xffff
    s_and_b32 s53, s53, 0xffff
    s_and_b32 s33, s33, 0xffff
    s_and_b32 s37, s37, 0xffff
    s_and_b32 s45, s45, 0xffff
    s_and_b32 s29, s29, 0xffff
    s_and_b32 s41, s41, 0xffff
    s_and_b32 s25, s25, 0xffff
    buffer_load_dwordx4 v[12:15], v6, s[8:11], 0 offen
    buffer_load_dwordx4 v[104:107], v6, s[8:11], 0 offen offset:128
    buffer_load_dwordx4 v[40:43], v4, s[20:23], 0 offen nt
    buffer_load_dwordx4 v[44:47], v4, s[20:23], s70 offen nt
    buffer_load_dwordx4 v[48:51], v4, s[20:23], s71 offen nt
    buffer_load_dwordx4 v[52:55], v4, s[20:23], s72 offen nt
    buffer_load_dwordx4 v[56:59], v4, s[20:23], s73 offen nt
    buffer_load_dwordx4 v[60:63], v4, s[20:23], s74 offen nt
    buffer_load_dwordx4 v[64:67], v4, s[20:23], s75 offen nt
    buffer_load_dwordx4 v[68:71], v4, s[20:23], s76 offen nt
    buffer_load_dwordx4 v[72:75], v5, s[20:23], 0 offen nt
    buffer_load_dwordx4 v[76:79], v5, s[20:23], s70 offen nt
    buffer_load_dwordx4 v[80:83], v5, s[20:23], s71 offen nt
    buffer_load_dwordx4 v[84:87], v5, s[20:23], s72 offen nt
    buffer_load_dwordx4 v[88:91], v5, s[20:23], s73 offen nt
    buffer_load_dwordx4 v[92:95], v5, s[20:23], s74 offen nt
    buffer_load_dwordx4 v[96:99], v5, s[20:23], s75 offen nt
    buffer_load_dwordx4 v[100:103], v5, s[20:23], s76 offen nt
    s_barrier
    v_and_b32 v6, 1, v1
    v_lshlrev_b32 v6, 4, v6
    v_lshlrev_b32_e64 v6, v6, 1
    v_bfe_u32 v7, v1, 1, 2
    v_cmp_eq_u32 vcc, 0, v7
    s_nop 1
    v_cndmask_b32 v156, 0, v6, vcc
    v_cmp_eq_u32 vcc, 1, v7
    s_nop 1
    v_cndmask_b32 v157, 0, v6, vcc
    v_cmp_eq_u32 vcc, 2, v7
    s_nop 1
    v_cndmask_b32 v158, 0, v6, vcc
    v_cmp_eq_u32 vcc, 3, v7
    s_nop 1
    v_cndmask_b32 v159, 0, v6, vcc
    v_and_b32 v6, 1, v2
    v_lshlrev_b32 v6, 7, v6
    v_and_b32 v7, 7, v1
    v_lshl_add_u32 v6, v7, 2, v6
    s_lshl_b32 s66, s61, 8
    s_waitcnt vmcnt(14)
    v_mul_u32_u24_sdwa v136, v12, v156 dst_sel:DWORD dst_unused:UNUSED_PAD src0_sel:WORD_0 src1_sel:DWORD
    v_mul_u32_u24_sdwa v137, v12, v157 dst_sel:DWORD dst_unused:UNUSED_PAD src0_sel:WORD_0 src1_sel:DWORD
    v_mul_u32_u24_sdwa v138, v12, v158 dst_sel:DWORD dst_unused:UNUSED_PAD src0_sel:WORD_0 src1_sel:DWORD
    v_mul_u32_u24_sdwa v139, v12, v159 dst_sel:DWORD dst_unused:UNUSED_PAD src0_sel:WORD_0 src1_sel:DWORD
    s_nop 1
    v_mfma_f32_16x16x32_bf16 v[144:147], v[40:43], v[136:139], 0
    v_mul_u32_u24_sdwa v140, v12, v156 dst_sel:DWORD dst_unused:UNUSED_PAD src0_sel:WORD_1 src1_sel:DWORD
    v_mul_u32_u24_sdwa v141, v12, v157 dst_sel:DWORD dst_unused:UNUSED_PAD src0_sel:WORD_1 src1_sel:DWORD
    v_mul_u32_u24_sdwa v142, v12, v158 dst_sel:DWORD dst_unused:UNUSED_PAD src0_sel:WORD_1 src1_sel:DWORD
    v_mul_u32_u24_sdwa v143, v12, v159 dst_sel:DWORD dst_unused:UNUSED_PAD src0_sel:WORD_1 src1_sel:DWORD
    s_nop 1
    v_mfma_f32_16x16x32_bf16 v[148:151], v[44:47], v[140:143], 0
    s_waitcnt vmcnt(12)
    v_mul_u32_u24_sdwa v136, v13, v156 dst_sel:DWORD dst_unused:UNUSED_PAD src0_sel:WORD_0 src1_sel:DWORD
    v_mul_u32_u24_sdwa v137, v13, v157 dst_sel:DWORD dst_unused:UNUSED_PAD src0_sel:WORD_0 src1_sel:DWORD
    v_mul_u32_u24_sdwa v138, v13, v158 dst_sel:DWORD dst_unused:UNUSED_PAD src0_sel:WORD_0 src1_sel:DWORD
    v_mul_u32_u24_sdwa v139, v13, v159 dst_sel:DWORD dst_unused:UNUSED_PAD src0_sel:WORD_0 src1_sel:DWORD
    s_nop 1
    v_mfma_f32_16x16x32_bf16 v[144:147], v[48:51], v[136:139], v[144:147]
    v_mul_u32_u24_sdwa v140, v13, v156 dst_sel:DWORD dst_unused:UNUSED_PAD src0_sel:WORD_1 src1_sel:DWORD
    v_mul_u32_u24_sdwa v141, v13, v157 dst_sel:DWORD dst_unused:UNUSED_PAD src0_sel:WORD_1 src1_sel:DWORD
    v_mul_u32_u24_sdwa v142, v13, v158 dst_sel:DWORD dst_unused:UNUSED_PAD src0_sel:WORD_1 src1_sel:DWORD
    v_mul_u32_u24_sdwa v143, v13, v159 dst_sel:DWORD dst_unused:UNUSED_PAD src0_sel:WORD_1 src1_sel:DWORD
    s_nop 1
    v_mfma_f32_16x16x32_bf16 v[148:151], v[52:55], v[140:143], v[148:151]
    s_waitcnt vmcnt(10)
    v_mul_u32_u24_sdwa v136, v14, v156 dst_sel:DWORD dst_unused:UNUSED_PAD src0_sel:WORD_0 src1_sel:DWORD
    v_mul_u32_u24_sdwa v137, v14, v157 dst_sel:DWORD dst_unused:UNUSED_PAD src0_sel:WORD_0 src1_sel:DWORD
    v_mul_u32_u24_sdwa v138, v14, v158 dst_sel:DWORD dst_unused:UNUSED_PAD src0_sel:WORD_0 src1_sel:DWORD
    v_mul_u32_u24_sdwa v139, v14, v159 dst_sel:DWORD dst_unused:UNUSED_PAD src0_sel:WORD_0 src1_sel:DWORD
    s_nop 1
    v_mfma_f32_16x16x32_bf16 v[144:147], v[56:59], v[136:139], v[144:147]
    v_mul_u32_u24_sdwa v140, v14, v156 dst_sel:DWORD dst_unused:UNUSED_PAD src0_sel:WORD_1 src1_sel:DWORD
    v_mul_u32_u24_sdwa v141, v14, v157 dst_sel:DWORD dst_unused:UNUSED_PAD src0_sel:WORD_1 src1_sel:DWORD
    v_mul_u32_u24_sdwa v142, v14, v158 dst_sel:DWORD dst_unused:UNUSED_PAD src0_sel:WORD_1 src1_sel:DWORD
    v_mul_u32_u24_sdwa v143, v14, v159 dst_sel:DWORD dst_unused:UNUSED_PAD src0_sel:WORD_1 src1_sel:DWORD
    s_nop 1
    v_mfma_f32_16x16x32_bf16 v[148:151], v[60:63], v[140:143], v[148:151]
    s_waitcnt vmcnt(8)
    v_mul_u32_u24_sdwa v136, v15, v156 dst_sel:DWORD dst_unused:UNUSED_PAD src0_sel:WORD_0 src1_sel:DWORD
    v_mul_u32_u24_sdwa v137, v15, v157 dst_sel:DWORD dst_unused:UNUSED_PAD src0_sel:WORD_0 src1_sel:DWORD
    v_mul_u32_u24_sdwa v138, v15, v158 dst_sel:DWORD dst_unused:UNUSED_PAD src0_sel:WORD_0 src1_sel:DWORD
    v_mul_u32_u24_sdwa v139, v15, v159 dst_sel:DWORD dst_unused:UNUSED_PAD src0_sel:WORD_0 src1_sel:DWORD
    s_nop 1
    v_mfma_f32_16x16x32_bf16 v[144:147], v[64:67], v[136:139], v[144:147]
    v_mul_u32_u24_sdwa v140, v15, v156 dst_sel:DWORD dst_unused:UNUSED_PAD src0_sel:WORD_1 src1_sel:DWORD
    v_mul_u32_u24_sdwa v141, v15, v157 dst_sel:DWORD dst_unused:UNUSED_PAD src0_sel:WORD_1 src1_sel:DWORD
    v_mul_u32_u24_sdwa v142, v15, v158 dst_sel:DWORD dst_unused:UNUSED_PAD src0_sel:WORD_1 src1_sel:DWORD
    v_mul_u32_u24_sdwa v143, v15, v159 dst_sel:DWORD dst_unused:UNUSED_PAD src0_sel:WORD_1 src1_sel:DWORD
    s_nop 1
    v_mfma_f32_16x16x32_bf16 v[148:151], v[68:71], v[140:143], v[148:151]
    s_waitcnt vmcnt(6)
    v_mul_u32_u24_sdwa v136, v104, v156 dst_sel:DWORD dst_unused:UNUSED_PAD src0_sel:WORD_0 src1_sel:DWORD
    v_mul_u32_u24_sdwa v137, v104, v157 dst_sel:DWORD dst_unused:UNUSED_PAD src0_sel:WORD_0 src1_sel:DWORD
    v_mul_u32_u24_sdwa v138, v104, v158 dst_sel:DWORD dst_unused:UNUSED_PAD src0_sel:WORD_0 src1_sel:DWORD
    v_mul_u32_u24_sdwa v139, v104, v159 dst_sel:DWORD dst_unused:UNUSED_PAD src0_sel:WORD_0 src1_sel:DWORD
    s_nop 1
    v_mfma_f32_16x16x32_bf16 v[144:147], v[72:75], v[136:139], v[144:147]
    v_mul_u32_u24_sdwa v140, v104, v156 dst_sel:DWORD dst_unused:UNUSED_PAD src0_sel:WORD_1 src1_sel:DWORD
    v_mul_u32_u24_sdwa v141, v104, v157 dst_sel:DWORD dst_unused:UNUSED_PAD src0_sel:WORD_1 src1_sel:DWORD
    v_mul_u32_u24_sdwa v142, v104, v158 dst_sel:DWORD dst_unused:UNUSED_PAD src0_sel:WORD_1 src1_sel:DWORD
    v_mul_u32_u24_sdwa v143, v104, v159 dst_sel:DWORD dst_unused:UNUSED_PAD src0_sel:WORD_1 src1_sel:DWORD
    s_nop 1
    v_mfma_f32_16x16x32_bf16 v[148:151], v[76:79], v[140:143], v[148:151]
    s_waitcnt vmcnt(4)
    v_mul_u32_u24_sdwa v136, v105, v156 dst_sel:DWORD dst_unused:UNUSED_PAD src0_sel:WORD_0 src1_sel:DWORD
    v_mul_u32_u24_sdwa v137, v105, v157 dst_sel:DWORD dst_unused:UNUSED_PAD src0_sel:WORD_0 src1_sel:DWORD
    v_mul_u32_u24_sdwa v138, v105, v158 dst_sel:DWORD dst_unused:UNUSED_PAD src0_sel:WORD_0 src1_sel:DWORD
    v_mul_u32_u24_sdwa v139, v105, v159 dst_sel:DWORD dst_unused:UNUSED_PAD src0_sel:WORD_0 src1_sel:DWORD
    s_nop 1
    v_mfma_f32_16x16x32_bf16 v[144:147], v[80:83], v[136:139], v[144:147]
    v_mul_u32_u24_sdwa v140, v105, v156 dst_sel:DWORD dst_unused:UNUSED_PAD src0_sel:WORD_1 src1_sel:DWORD
    v_mul_u32_u24_sdwa v141, v105, v157 dst_sel:DWORD dst_unused:UNUSED_PAD src0_sel:WORD_1 src1_sel:DWORD
    v_mul_u32_u24_sdwa v142, v105, v158 dst_sel:DWORD dst_unused:UNUSED_PAD src0_sel:WORD_1 src1_sel:DWORD
    v_mul_u32_u24_sdwa v143, v105, v159 dst_sel:DWORD dst_unused:UNUSED_PAD src0_sel:WORD_1 src1_sel:DWORD
    s_nop 1
    v_mfma_f32_16x16x32_bf16 v[148:151], v[84:87], v[140:143], v[148:151]
    s_waitcnt vmcnt(2)
    v_mul_u32_u24_sdwa v136, v106, v156 dst_sel:DWORD dst_unused:UNUSED_PAD src0_sel:WORD_0 src1_sel:DWORD
    v_mul_u32_u24_sdwa v137, v106, v157 dst_sel:DWORD dst_unused:UNUSED_PAD src0_sel:WORD_0 src1_sel:DWORD
    v_mul_u32_u24_sdwa v138, v106, v158 dst_sel:DWORD dst_unused:UNUSED_PAD src0_sel:WORD_0 src1_sel:DWORD
    v_mul_u32_u24_sdwa v139, v106, v159 dst_sel:DWORD dst_unused:UNUSED_PAD src0_sel:WORD_0 src1_sel:DWORD
    s_nop 1
    v_mfma_f32_16x16x32_bf16 v[144:147], v[88:91], v[136:139], v[144:147]
    v_mul_u32_u24_sdwa v140, v106, v156 dst_sel:DWORD dst_unused:UNUSED_PAD src0_sel:WORD_1 src1_sel:DWORD
    v_mul_u32_u24_sdwa v141, v106, v157 dst_sel:DWORD dst_unused:UNUSED_PAD src0_sel:WORD_1 src1_sel:DWORD
    v_mul_u32_u24_sdwa v142, v106, v158 dst_sel:DWORD dst_unused:UNUSED_PAD src0_sel:WORD_1 src1_sel:DWORD
    v_mul_u32_u24_sdwa v143, v106, v159 dst_sel:DWORD dst_unused:UNUSED_PAD src0_sel:WORD_1 src1_sel:DWORD
    s_nop 1
    v_mfma_f32_16x16x32_bf16 v[148:151], v[92:95], v[140:143], v[148:151]
    s_waitcnt vmcnt(0)
    v_mul_u32_u24_sdwa v136, v107, v156 dst_sel:DWORD dst_unused:UNUSED_PAD src0_sel:WORD_0 src1_sel:DWORD
    v_mul_u32_u24_sdwa v137, v107, v157 dst_sel:DWORD dst_unused:UNUSED_PAD src0_sel:WORD_0 src1_sel:DWORD
    v_mul_u32_u24_sdwa v138, v107, v158 dst_sel:DWORD dst_unused:UNUSED_PAD src0_sel:WORD_0 src1_sel:DWORD
    v_mul_u32_u24_sdwa v139, v107, v159 dst_sel:DWORD dst_unused:UNUSED_PAD src0_sel:WORD_0 src1_sel:DWORD
    s_nop 1
    v_mfma_f32_16x16x32_bf16 v[144:147], v[96:99], v[136:139], v[144:147]
    v_mul_u32_u24_sdwa v140, v107, v156 dst_sel:DWORD dst_unused:UNUSED_PAD src0_sel:WORD_1 src1_sel:DWORD
    v_mul_u32_u24_sdwa v141, v107, v157 dst_sel:DWORD dst_unused:UNUSED_PAD src0_sel:WORD_1 src1_sel:DWORD
    v_mul_u32_u24_sdwa v142, v107, v158 dst_sel:DWORD dst_unused:UNUSED_PAD src0_sel:WORD_1 src1_sel:DWORD
    v_mul_u32_u24_sdwa v143, v107, v159 dst_sel:DWORD dst_unused:UNUSED_PAD src0_sel:WORD_1 src1_sel:DWORD
    s_nop 1
    v_mfma_f32_16x16x32_bf16 v[148:151], v[100:103], v[140:143], v[148:151]
    s_nop 7
    v_add_f32 v144, v144, v148
    v_add_f32 v145, v145, v149
    v_add_f32 v146, v146, v150
    v_add_f32 v147, v147, v151
    s_mov_b32 exec_lo, 0x00ff00ff
    s_mov_b32 exec_hi, 0xff00ff00
    ds_add_f32 v6, v144 offset:256
    ds_add_f32 v6, v145 offset:288
    ds_add_f32 v6, v146 offset:320
    ds_add_f32 v6, v147 offset:352
    s_mov_b64 exec, 1
    ds_add_rtn_u32 v7, v9, v10 offset:0
    s_mov_b64 exec, -1
    s_waitcnt lgkmcnt(0)
    v_readfirstlane_b32 s87, v7
    s_cmp_lg_u32 s87, 1
    s_cbranch_scc1 s_join
s_s0:
    ds_read_b32 v6, v9 offset:4
    ds_read_b128 v[40:43], v8 offset:256
    s_waitcnt lgkmcnt(0)
    v_readfirstlane_b32 s92, v6
    s_cmp_ge_u32 s92, 2
    s_cbranch_scc1 s_s0_d
    s_sub_u32 s90, s90, 1
    s_cbranch_scc0 s_s0
    s_endpgm
s_s0_d:
    v_min_u32 v40, -2, v40
    v_min_u32 v41, -2, v41
    v_min_u32 v42, -2, v42
    v_min_u32 v43, -2, v43
    s_mov_b64 exec, 0xffff
    buffer_store_dwordx4 v[40:43], v8, s[56:59], s66 offen sc1
    s_mov_b64 exec, 1
    ds_add_u32 v9, v10 offset:4
    s_mov_b64 exec, -1
    s_branch s_join
s_ctl:
    v_mov_b32 v160, -1
    v_mov_b32 v161, -1
    v_mov_b32 v162, -1
    v_mov_b32 v163, -1
    s_lshl_b32 s65, s61, 13
    s_add_u32 s65, s65, 0x400000
    s_add_u32 s67, s65, 4096
    s_add_u32 s66, s69, 0x40000
    s_lshl_b32 s74, s63, 10
    s_add_u32 s74, s74, 0x30000
    v_lshlrev_b32 v6, 7, v0
    s_lshl_b32 s70, s63, 14
    s_add_u32 s71, s70, 4096
    s_add_u32 s72, s70, 8192
    s_add_u32 s73, s70, 12288
    v_mul_u32_u24 v7, 3584, v2
    v_lshl_add_u32 v7, v1, 4, v7
    s_cmp_eq_u32 s62, 2
    s_cbranch_scc1 s_c2
    s_waitcnt lgkmcnt(0)
    s_and_b32 s9, s9, 0xffff
    s_and_b32 s21, s21, 0xffff
    s_and_b32 s57, s57, 0xffff
    s_and_b32 s53, s53, 0xffff
    s_and_b32 s33, s33, 0xffff
    s_and_b32 s37, s37, 0xffff
    s_and_b32 s45, s45, 0xffff
    s_and_b32 s29, s29, 0xffff
    s_and_b32 s41, s41, 0xffff
    s_and_b32 s25, s25, 0xffff
    buffer_store_dwordx4 v[160:163], v8, s[56:59], s65 offen offset:0 sc1
    buffer_store_dwordx4 v[160:163], v8, s[56:59], s65 offen offset:1024 sc1
    buffer_store_dwordx4 v[160:163], v8, s[56:59], s65 offen offset:2048 sc1
    buffer_store_dwordx4 v[160:163], v8, s[56:59], s65 offen offset:3072 sc1
    buffer_store_dwordx4 v[160:163], v8, s[56:59], s67 offen offset:0 sc1
    buffer_store_dwordx4 v[160:163], v8, s[56:59], s67 offen offset:1024 sc1
    buffer_store_dwordx4 v[160:163], v8, s[56:59], s67 offen offset:2048 sc1
    buffer_store_dwordx4 v[160:163], v8, s[56:59], s67 offen offset:3072 sc1
    s_cmp_ge_u32 s64, 56
    s_cbranch_scc1 s_c3n
    s_mov_b32 exec_hi, 0
    buffer_store_dwordx4 v[160:163], v7, s[56:59], s5 offen sc1
s_c3n:
    s_mov_b64 exec, -1
    buffer_store_dwordx4 v[160:163], v8, s[56:59], s66 offen offset:0 sc1
    buffer_store_dwordx4 v[160:163], v8, s[56:59], s66 offen offset:1024 sc1
    buffer_store_dwordx4 v[160:163], v8, s[56:59], s66 offen offset:2048 sc1
    buffer_store_dwordx4 v[160:163], v8, s[56:59], s66 offen offset:3072 sc1
    s_barrier
    v_and_b32 v6, 1, v1
    v_lshlrev_b32 v6, 4, v6
    v_lshlrev_b32_e64 v6, v6, 1
    v_bfe_u32 v7, v1, 1, 2
    v_cmp_eq_u32 vcc, 0, v7
    s_nop 1
    v_cndmask_b32 v156, 0, v6, vcc
    v_cmp_eq_u32 vcc, 1, v7
    s_nop 1
    v_cndmask_b32 v157, 0, v6, vcc
    v_cmp_eq_u32 vcc, 2, v7
    s_nop 1
    v_cndmask_b32 v158, 0, v6, vcc
    v_cmp_eq_u32 vcc, 3, v7
    s_nop 1
    v_cndmask_b32 v159, 0, v6, vcc
    s_waitcnt vmcnt(0)
    s_mov_b64 exec, 1
    ds_add_u32 v9, v10 offset:4
    s_mov_b64 exec, -1
    s_branch s_join
s_c2:
    v_mov_b32 v144, 0
    v_mov_b32 v145, 0
    v_mov_b32 v146, 0
    v_mov_b32 v147, 0
    ds_write_b128 v8, v[144:147]
    s_waitcnt lgkmcnt(0)
    s_and_b32 s9, s9, 0xffff
    s_and_b32 s21, s21, 0xffff
    s_and_b32 s57, s57, 0xffff
    s_and_b32 s53, s53, 0xffff
    s_and_b32 s33, s33, 0xffff
    s_and_b32 s37, s37, 0xffff
    s_and_b32 s45, s45, 0xffff
    s_and_b32 s29, s29, 0xffff
    s_and_b32 s41, s41, 0xffff
    s_and_b32 s25, s25, 0xffff
    s_cmp_lg_u32 s64, 56
    s_cbranch_scc1 s_c2n
    buffer_store_dwordx4 v[160:163], v8, s[56:59], s70 offen offset:0 sc1
    buffer_store_dwordx4 v[160:163], v8, s[56:59], s70 offen offset:1024 sc1
    buffer_store_dwordx4 v[160:163], v8, s[56:59], s70 offen offset:2048 sc1
    buffer_store_dwordx4 v[160:163], v8, s[56:59], s70 offen offset:3072 sc1
    buffer_store_dwordx4 v[160:163], v8, s[56:59], s71 offen offset:0 sc1
    buffer_store_dwordx4 v[160:163], v8, s[56:59], s71 offen offset:1024 sc1
    buffer_store_dwordx4 v[160:163], v8, s[56:59], s71 offen offset:2048 sc1
    buffer_store_dwordx4 v[160:163], v8, s[56:59], s71 offen offset:3072 sc1
    buffer_store_dwordx4 v[160:163], v8, s[56:59], s72 offen offset:0 sc1
    buffer_store_dwordx4 v[160:163], v8, s[56:59], s72 offen offset:1024 sc1
    buffer_store_dwordx4 v[160:163], v8, s[56:59], s72 offen offset:2048 sc1
    buffer_store_dwordx4 v[160:163], v8, s[56:59], s72 offen offset:3072 sc1
    buffer_store_dwordx4 v[160:163], v8, s[56:59], s73 offen offset:0 sc1
    buffer_store_dwordx4 v[160:163], v8, s[56:59], s73 offen offset:1024 sc1
    buffer_store_dwordx4 v[160:163], v8, s[56:59], s73 offen offset:2048 sc1
    buffer_store_dwordx4 v[160:163], v8, s[56:59], s73 offen offset:3072 sc1
    s_mov_b64 exec, 0xff
    buffer_store_dword v9, v6, s[56:59], s74 offen sc1
    s_barrier
    s_mov_b64 exec, 1
    s_waitcnt vmcnt(0)
    buffer_store_dword v10, v9, s[52:55], s6 offen sc1
    s_branch s_pf_d
s_c2n:
    s_barrier
    s_mov_b64 exec, 1
s_pf:
    buffer_load_dword v6, v9, s[52:55], s6 offen sc1
    s_waitcnt vmcnt(0)
    v_cmp_eq_u32 vcc, 0, v6
    s_cbranch_vccz s_pf_d
    s_sub_u32 s91, s91, 1
    s_cbranch_scc0 s_pf
    s_endpgm
s_pf_d:
    s_mov_b64 exec, 1
    ds_add_u32 v9, v10 offset:4
    s_mov_b64 exec, -1
    v_and_b32 v6, 1, v1
    v_lshlrev_b32 v6, 4, v6
    v_lshlrev_b32_e64 v6, v6, 1
    v_bfe_u32 v7, v1, 1, 2
    v_cmp_eq_u32 vcc, 0, v7
    s_nop 1
    v_cndmask_b32 v156, 0, v6, vcc
    v_cmp_eq_u32 vcc, 1, v7
    s_nop 1
    v_cndmask_b32 v157, 0, v6, vcc
    v_cmp_eq_u32 vcc, 2, v7
    s_nop 1
    v_cndmask_b32 v158, 0, v6, vcc
    v_cmp_eq_u32 vcc, 3, v7
    s_nop 1
    v_cndmask_b32 v159, 0, v6, vcc
s_join:
    s_lshl_b32 s70, s63, 14
    s_lshl_b32 s71, s62, 10
    s_add_u32 s68, s69, s71
    s_lshl_b32 s68, s68, 1
    s_add_u32 s68, s68, 0x400000
    s_add_u32 s70, s70, s71
    s_add_u32 s71, s70, 4096
    s_add_u32 s72, s70, 8192
    s_add_u32 s73, s70, 12288
    v_lshrrev_b32 v6, 5, v0
    v_mul_u32_u24 v6, 272, v6
    v_and_b32 v7, 31, v0
    v_lshl_add_u32 v4, v7, 3, v6
    s_mul_i32 s76, s62, 544
    v_add_u32 v4, s76, v4
    s_lshl_b32 s65, s3, 8
    s_lshl_b32 s66, s62, 6
    s_add_u32 s65, s65, s66
    v_add_u32 v3, s65, v3
    s_mul_i32 s66, s63, 14
    s_add_u32 s66, s66, s4
    s_lshl_b32 s66, s66, 7
    v_mul_u32_u24 v5, 0x1c00, v3
    v_add3_u32 v5, v5, v11, s66
    v_lshlrev_b32 v3, 1, v3
    s_mov_b32 s77, 7168
    s_mov_b32 s78, 14336
    s_mov_b32 s79, 21504
    s_mov_b32 s80, 28672
    s_mov_b32 s81, 35840
    s_mov_b32 s82, 43008
    s_mov_b32 s83, 50176
    v_lshlrev_b32 v6, 11, v2
    v_lshl_add_u32 v160, v1, 4, v6
    v_mov_b32 v7, 0x7f000000
    v_cmp_gt_u32 vcc, 2, v2
    s_nop 1
    v_cndmask_b32 v161, v7, v160, vcc
    s_mul_i32 s48, s61, 28672
    s_lshl_b32 s49, s62, 9
    s_add_u32 s48, s48, s49
    s_add_u32 s49, s48, 8192
    s_add_u32 s50, s48, 16384
    s_add_u32 s51, s48, 24576
s_s1:
    ds_read_b32 v6, v9 offset:4
    s_waitcnt lgkmcnt(0)
    v_readfirstlane_b32 s92, v6
    s_cmp_ge_u32 s92, 3
    s_cbranch_scc1 s_s1_d
    s_sub_u32 s90, s90, 1
    s_cbranch_scc0 s_s1
    s_endpgm
s_s1_d:
s_pq:
    buffer_load_dwordx4 v[40:43], v8, s[56:59], s70 offen sc1
    buffer_load_dwordx4 v[44:47], v8, s[56:59], s71 offen sc1
    buffer_load_dwordx4 v[48:51], v8, s[56:59], s72 offen sc1
    buffer_load_dwordx4 v[52:55], v8, s[56:59], s73 offen sc1
    s_waitcnt vmcnt(0)
    v_max3_u32 v6, v40, v41, v42
    v_max3_u32 v6, v6, v43, v44
    v_max3_u32 v6, v6, v45, v46
    v_max3_u32 v6, v6, v47, v48
    v_max3_u32 v6, v6, v49, v50
    v_max3_u32 v6, v6, v51, v52
    v_max3_u32 v6, v6, v53, v54
    v_max_u32 v6, v6, v55
    v_cmp_eq_u32 vcc, -1, v6
    s_cbranch_vccz s_pq_d
    s_mov_b64 exec, vcc
    s_sub_u32 s91, s91, 1
    s_cbranch_scc0 s_pq
    s_endpgm
s_pq_d:
    s_mov_b64 exec, -1
    v_add_f32 v40, v40, v44
    v_add_f32 v48, v48, v52
    v_add_f32 v41, v41, v45
    v_add_f32 v49, v49, v53
    v_add_f32 v42, v42, v46
    v_add_f32 v50, v50, v54
    v_add_f32 v43, v43, v47
    v_add_f32 v51, v51, v55
    v_add_f32 v40, v40, v48
    v_add_f32 v41, v41, v49
    v_add_f32 v42, v42, v50
    v_add_f32 v43, v43, v51
    v_cvt_pk_bf16_f32 v40, v40, v41
    v_cvt_pk_bf16_f32 v41, v42, v43
    ds_write_b64 v4, v[40:41] offset:1024
    s_mov_b64 exec, 1
    ds_add_u32 v9, v10 offset:8
    s_mov_b64 exec, -1
    s_cmp_lg_u32 s64, 56
    s_cbranch_scc1 s_nf2
    s_cmp_lg_u32 s62, 2
    s_cbranch_scc1 s_nf2
s_f2:
    ds_read_b32 v6, v9 offset:8
    s_waitcnt lgkmcnt(0)
    v_readfirstlane_b32 s92, v6
    s_cmp_ge_u32 s92, 4
    s_cbranch_scc1 s_f2_d
    s_sub_u32 s90, s90, 1
    s_cbranch_scc0 s_f2
    s_endpgm
s_f2_d:
    s_mov_b64 exec, 1
    buffer_store_dword v10, v9, s[52:55], s6 offen offset:4 sc1
    s_mov_b64 exec, -1
s_nf2:
    s_cmp_ge_u32 s64, 56
    s_cbranch_scc1 s_nogu
    buffer_load_dwordx4 v[12:15], v3, s[8:11], 0 offen
    buffer_load_dwordx4 v[72:75], v5, s[32:35], 0 offen nt
    buffer_load_dwordx4 v[76:79], v5, s[32:35], s77 offen nt
    buffer_load_dwordx4 v[80:83], v5, s[32:35], s78 offen nt
    buffer_load_dwordx4 v[84:87], v5, s[32:35], s79 offen nt
    buffer_load_dwordx4 v[88:91], v5, s[32:35], s80 offen nt
    buffer_load_dwordx4 v[92:95], v5, s[32:35], s81 offen nt
    buffer_load_dwordx4 v[96:99], v5, s[32:35], s82 offen nt
    buffer_load_dwordx4 v[100:103], v5, s[32:35], s83 offen nt
    buffer_load_dwordx4 v[104:107], v5, s[36:39], 0 offen nt
    buffer_load_dwordx4 v[108:111], v5, s[36:39], s77 offen nt
    buffer_load_dwordx4 v[112:115], v5, s[36:39], s78 offen nt
    buffer_load_dwordx4 v[116:119], v5, s[36:39], s79 offen nt
    buffer_load_dwordx4 v[120:123], v5, s[36:39], s80 offen nt
    buffer_load_dwordx4 v[124:127], v5, s[36:39], s81 offen nt
    buffer_load_dwordx4 v[128:131], v5, s[36:39], s82 offen nt
    buffer_load_dwordx4 v[132:135], v5, s[36:39], s83 offen nt
s_nogu:
    v_lshlrev_b32 v7, 5, v0
    buffer_load_dwordx4 v[16:19], v7, s[8:11], 0 offen
    buffer_load_dwordx4 v[20:23], v7, s[8:11], 0 offen offset:16
    buffer_load_dwordx4 v[24:27], v7, s[44:47], 0 offen
    buffer_load_dwordx4 v[28:31], v7, s[44:47], 0 offen offset:16
    buffer_load_dwordx4 v[32:35], v7, s[28:31], 0 offen
    buffer_load_dwordx4 v[36:39], v7, s[28:31], 0 offen offset:16
    s_lshl_b32 s85, s63, 3
    s_and_b32 s86, s64, 7
    s_add_u32 s85, s85, s86
    s_lshl_b32 s85, s85, 6
    v_and_b32 v3, 31, v0
    v_lshlrev_b32 v3, 1, v3
    buffer_load_ushort v164, v3, s[8:11], s85 offen
    s_waitcnt lgkmcnt(0)
    buffer_load_dwordx4 v[40:43], v160, s[40:43], s48 offen offset:0 nt
    buffer_load_dwordx4 v[44:47], v160, s[40:43], s48 offen offset:256 nt
    buffer_load_dwordx4 v[48:51], v160, s[40:43], s49 offen offset:0 nt
    buffer_load_dwordx4 v[52:55], v160, s[40:43], s49 offen offset:256 nt
    buffer_load_dwordx4 v[56:59], v160, s[40:43], s50 offen offset:0 nt
    buffer_load_dwordx4 v[60:63], v160, s[40:43], s50 offen offset:256 nt
    buffer_load_dwordx4 v[64:67], v161, s[40:43], s51 offen offset:0 nt
    buffer_load_dwordx4 v[68:71], v161, s[40:43], s51 offen offset:256 nt
    v_lshlrev_b32 v3, 4, v2
    s_cmp_ge_u32 s64, 56
    s_cbranch_scc1 s_nogu2
    v_and_b32 v6, 1, v2
    v_lshlrev_b32 v6, 7, v6
    v_and_b32 v7, 7, v1
    v_lshl_add_u32 v6, v7, 2, v6
    v_mul_u32_u24 v4, 3584, v2
    v_lshl_add_u32 v4, v1, 4, v4
    s_waitcnt vmcnt(15)
    v_mul_u32_u24_sdwa v136, v12, v156 dst_sel:DWORD dst_unused:UNUSED_PAD src0_sel:WORD_0 src1_sel:DWORD
    v_mul_u32_u24_sdwa v137, v12, v157 dst_sel:DWORD dst_unused:UNUSED_PAD src0_sel:WORD_0 src1_sel:DWORD
    v_mul_u32_u24_sdwa v138, v12, v158 dst_sel:DWORD dst_unused:UNUSED_PAD src0_sel:WORD_0 src1_sel:DWORD
    v_mul_u32_u24_sdwa v139, v12, v159 dst_sel:DWORD dst_unused:UNUSED_PAD src0_sel:WORD_0 src1_sel:DWORD
    s_nop 1
    v_mfma_f32_16x16x32_bf16 v[144:147], v[72:75], v[136:139], 0
    v_mfma_f32_16x16x32_bf16 v[148:151], v[104:107], v[136:139], 0
    v_mul_u32_u24_sdwa v140, v12, v156 dst_sel:DWORD dst_unused:UNUSED_PAD src0_sel:WORD_1 src1_sel:DWORD
    v_mul_u32_u24_sdwa v141, v12, v157 dst_sel:DWORD dst_unused:UNUSED_PAD src0_sel:WORD_1 src1_sel:DWORD
    v_mul_u32_u24_sdwa v142, v12, v158 dst_sel:DWORD dst_unused:UNUSED_PAD src0_sel:WORD_1 src1_sel:DWORD
    v_mul_u32_u24_sdwa v143, v12, v159 dst_sel:DWORD dst_unused:UNUSED_PAD src0_sel:WORD_1 src1_sel:DWORD
    s_nop 1
    v_mfma_f32_16x16x32_bf16 v[144:147], v[76:79], v[140:143], v[144:147]
    v_mfma_f32_16x16x32_bf16 v[148:151], v[108:111], v[140:143], v[148:151]
    v_mul_u32_u24_sdwa v136, v13, v156 dst_sel:DWORD dst_unused:UNUSED_PAD src0_sel:WORD_0 src1_sel:DWORD
    v_mul_u32_u24_sdwa v137, v13, v157 dst_sel:DWORD dst_unused:UNUSED_PAD src0_sel:WORD_0 src1_sel:DWORD
    v_mul_u32_u24_sdwa v138, v13, v158 dst_sel:DWORD dst_unused:UNUSED_PAD src0_sel:WORD_0 src1_sel:DWORD
    v_mul_u32_u24_sdwa v139, v13, v159 dst_sel:DWORD dst_unused:UNUSED_PAD src0_sel:WORD_0 src1_sel:DWORD
    s_nop 1
    v_mfma_f32_16x16x32_bf16 v[144:147], v[80:83], v[136:139], v[144:147]
    v_mfma_f32_16x16x32_bf16 v[148:151], v[112:115], v[136:139], v[148:151]
    v_mul_u32_u24_sdwa v140, v13, v156 dst_sel:DWORD dst_unused:UNUSED_PAD src0_sel:WORD_1 src1_sel:DWORD
    v_mul_u32_u24_sdwa v141, v13, v157 dst_sel:DWORD dst_unused:UNUSED_PAD src0_sel:WORD_1 src1_sel:DWORD
    v_mul_u32_u24_sdwa v142, v13, v158 dst_sel:DWORD dst_unused:UNUSED_PAD src0_sel:WORD_1 src1_sel:DWORD
    v_mul_u32_u24_sdwa v143, v13, v159 dst_sel:DWORD dst_unused:UNUSED_PAD src0_sel:WORD_1 src1_sel:DWORD
    s_nop 1
    v_mfma_f32_16x16x32_bf16 v[144:147], v[84:87], v[140:143], v[144:147]
    v_mfma_f32_16x16x32_bf16 v[148:151], v[116:119], v[140:143], v[148:151]
    v_mul_u32_u24_sdwa v136, v14, v156 dst_sel:DWORD dst_unused:UNUSED_PAD src0_sel:WORD_0 src1_sel:DWORD
    v_mul_u32_u24_sdwa v137, v14, v157 dst_sel:DWORD dst_unused:UNUSED_PAD src0_sel:WORD_0 src1_sel:DWORD
    v_mul_u32_u24_sdwa v138, v14, v158 dst_sel:DWORD dst_unused:UNUSED_PAD src0_sel:WORD_0 src1_sel:DWORD
    v_mul_u32_u24_sdwa v139, v14, v159 dst_sel:DWORD dst_unused:UNUSED_PAD src0_sel:WORD_0 src1_sel:DWORD
    s_nop 1
    v_mfma_f32_16x16x32_bf16 v[144:147], v[88:91], v[136:139], v[144:147]
    v_mfma_f32_16x16x32_bf16 v[148:151], v[120:123], v[136:139], v[148:151]
    v_mul_u32_u24_sdwa v140, v14, v156 dst_sel:DWORD dst_unused:UNUSED_PAD src0_sel:WORD_1 src1_sel:DWORD
    v_mul_u32_u24_sdwa v141, v14, v157 dst_sel:DWORD dst_unused:UNUSED_PAD src0_sel:WORD_1 src1_sel:DWORD
    v_mul_u32_u24_sdwa v142, v14, v158 dst_sel:DWORD dst_unused:UNUSED_PAD src0_sel:WORD_1 src1_sel:DWORD
    v_mul_u32_u24_sdwa v143, v14, v159 dst_sel:DWORD dst_unused:UNUSED_PAD src0_sel:WORD_1 src1_sel:DWORD
    s_nop 1
    v_mfma_f32_16x16x32_bf16 v[144:147], v[92:95], v[140:143], v[144:147]
    v_mfma_f32_16x16x32_bf16 v[148:151], v[124:127], v[140:143], v[148:151]
    v_mul_u32_u24_sdwa v136, v15, v156 dst_sel:DWORD dst_unused:UNUSED_PAD src0_sel:WORD_0 src1_sel:DWORD
    v_mul_u32_u24_sdwa v137, v15, v157 dst_sel:DWORD dst_unused:UNUSED_PAD src0_sel:WORD_0 src1_sel:DWORD
    v_mul_u32_u24_sdwa v138, v15, v158 dst_sel:DWORD dst_unused:UNUSED_PAD src0_sel:WORD_0 src1_sel:DWORD
    v_mul_u32_u24_sdwa v139, v15, v159 dst_sel:DWORD dst_unused:UNUSED_PAD src0_sel:WORD_0 src1_sel:DWORD
    s_nop 1
    v_mfma_f32_16x16x32_bf16 v[144:147], v[96:99], v[136:139], v[144:147]
    v_mfma_f32_16x16x32_bf16 v[148:151], v[128:131], v[136:139], v[148:151]
    v_mul_u32_u24_sdwa v140, v15, v156 dst_sel:DWORD dst_unused:UNUSED_PAD src0_sel:WORD_1 src1_sel:DWORD
    v_mul_u32_u24_sdwa v141, v15, v157 dst_sel:DWORD dst_unused:UNUSED_PAD src0_sel:WORD_1 src1_sel:DWORD
    v_mul_u32_u24_sdwa v142, v15, v158 dst_sel:DWORD dst_unused:UNUSED_PAD src0_sel:WORD_1 src1_sel:DWORD
    v_mul_u32_u24_sdwa v143, v15, v159 dst_sel:DWORD dst_unused:UNUSED_PAD src0_sel:WORD_1 src1_sel:DWORD
    s_nop 1
    v_mfma_f32_16x16x32_bf16 v[144:147], v[100:103], v[140:143], v[144:147]
    v_mfma_f32_16x16x32_bf16 v[148:151], v[132:135], v[140:143], v[148:151]
    s_mov_b32 exec_lo, 0x00ff00ff
    s_mov_b32 exec_hi, 0xff00ff00
    s_nop 4
    ds_add_f32 v6, v144 offset:512
    ds_add_f32 v6, v145 offset:544
    ds_add_f32 v6, v146 offset:576
    ds_add_f32 v6, v147 offset:608
    ds_add_f32 v6, v148 offset:768
    ds_add_f32 v6, v149 offset:800
    ds_add_f32 v6, v150 offset:832
    ds_add_f32 v6, v151 offset:864
    s_mov_b64 exec, 1
    ds_add_rtn_u32 v7, v9, v10 offset:32
    s_mov_b64 exec, -1
    s_waitcnt lgkmcnt(0)
    v_readfirstlane_b32 s87, v7
    s_cmp_lg_u32 s87, 3
    s_cbranch_scc1 s_nogu2
    s_mov_b32 exec_hi, 0
    ds_read_b128 v[136:139], v8 offset:512
    s_waitcnt lgkmcnt(0)
    v_min_u32 v136, -2, v136
    v_min_u32 v137, -2, v137
    v_min_u32 v138, -2, v138
    v_min_u32 v139, -2, v139
    buffer_store_dwordx4 v[136:139], v4, s[56:59], s5 offen sc1
    s_mov_b64 exec, -1
s_nogu2:
    s_lshl_b32 s77, s62, 9
    s_lshr_b32 s81, s61, 3
    s_lshl_b32 s81, s81, 7
    s_bfe_u32 s82, s61, 0x20001
    s_lshl_b32 s82, s82, 5
    s_add_u32 s81, s81, s82
    s_and_b32 s82, s61, 1
    s_lshl_b32 s82, s82, 2
    s_add_u32 s81, s81, s82
    s_lshl_b32 s81, s81, 11
    s_add_u32 s81, s81, s77
    s_add_u32 s82, s81, 16384
    s_add_u32 s83, s81, 32768
    s_add_u32 s84, s81, 49152
    buffer_load_dwordx4 v[72:75], v160, s[24:27], s81 offen offset:0 nt
    buffer_load_dwordx4 v[76:79], v160, s[24:27], s81 offen offset:256 nt
    buffer_load_dwordx4 v[80:83], v160, s[24:27], s82 offen offset:0 nt
    buffer_load_dwordx4 v[84:87], v160, s[24:27], s82 offen offset:256 nt
    buffer_load_dwordx4 v[88:91], v160, s[24:27], s83 offen offset:0 nt
    buffer_load_dwordx4 v[92:95], v160, s[24:27], s83 offen offset:256 nt
    buffer_load_dwordx4 v[96:99], v160, s[24:27], s84 offen offset:0 nt
    buffer_load_dwordx4 v[100:103], v160, s[24:27], s84 offen offset:256 nt
    s_waitcnt vmcnt(16)
    v_mov_b32 v165, 0
    v_mov_b32 v166, 0
    v_dot2c_f32_bf16 v165, v16, v24
    v_dot2c_f32_bf16 v165, v17, v25
    v_dot2c_f32_bf16 v165, v18, v26
    v_dot2c_f32_bf16 v165, v19, v27
    v_dot2c_f32_bf16 v165, v20, v28
    v_dot2c_f32_bf16 v165, v21, v29
    v_dot2c_f32_bf16 v165, v22, v30
    v_dot2c_f32_bf16 v165, v23, v31
    v_dot2c_f32_bf16 v166, v16, v32
    v_dot2c_f32_bf16 v166, v17, v33
    v_dot2c_f32_bf16 v166, v18, v34
    v_dot2c_f32_bf16 v166, v19, v35
    v_dot2c_f32_bf16 v166, v20, v36
    v_dot2c_f32_bf16 v166, v21, v37
    v_dot2c_f32_bf16 v166, v22, v38
    v_dot2c_f32_bf16 v166, v23, v39
    v_add_f32_dpp v165, v165, v165 quad_perm:[1,0,3,2] row_mask:0xf bank_mask:0xf
    s_nop 1
    v_add_f32_dpp v166, v166, v166 quad_perm:[1,0,3,2] row_mask:0xf bank_mask:0xf
    v_add_f32_dpp v165, v165, v165 quad_perm:[2,3,0,1] row_mask:0xf bank_mask:0xf
    s_nop 0
    v_add_f32_dpp v166, v166, v166 quad_perm:[2,3,0,1] row_mask:0xf bank_mask:0xf
    v_add_f32_dpp v165, v165, v165 row_ror:4 row_mask:0xf bank_mask:0xf
    s_nop 0
    v_add_f32_dpp v166, v166, v166 row_ror:4 row_mask:0xf bank_mask:0xf
    v_add_f32_dpp v165, v165, v165 row_ror:8 row_mask:0xf bank_mask:0xf
    s_nop 0
    v_add_f32_dpp v166, v166, v166 row_ror:8 row_mask:0xf bank_mask:0xf
    v_mov_b32 v6, v165
    s_nop 1
    v_permlane16_swap_b32 v165, v6
    v_add_f32 v165, v165, v6
    v_mov_b32 v6, v165
    s_nop 1
    v_permlane32_swap_b32 v165, v6
    v_add_f32 v165, v165, v6
    v_mov_b32 v7, v166
    s_nop 1
    v_permlane16_swap_b32 v166, v7
    v_add_f32 v166, v166, v7
    v_mov_b32 v7, v166
    s_nop 1
    v_permlane32_swap_b32 v166, v7
    v_add_f32 v166, v166, v7
    v_cvt_pk_bf16_f32 v165, v165, v165
    v_lshlrev_b32 v165, 16, v165
    v_cvt_pk_bf16_f32 v166, v166, v166
    v_lshlrev_b32 v166, 16, v166
    v_mul_f32 v165, 0xbfb8aa3b, v165
    v_exp_f32 v165, v165
    s_nop 0
    v_add_f32 v165, 1.0, v165
    v_rcp_f32 v165, v165
    s_nop 0
    v_cvt_pk_bf16_f32 v165, v165, v165
    v_lshlrev_b32 v165, 16, v165
    v_mul_f32 v166, 0xbfb8aa3b, v166
    v_exp_f32 v166, v166
    s_nop 0
    v_add_f32 v166, 1.0, v166
    v_rcp_f32 v166, v166
    s_nop 0
    v_cvt_pk_bf16_f32 v166, v166, v166
    v_lshlrev_b32 v166, 16, v166
    v_sub_f32 v167, 1.0, v165
    v_cvt_pk_bf16_f32 v167, v167, v167
    v_lshlrev_b32 v167, 16, v167
    v_mul_f32 v166, v166, v167
    v_lshlrev_b32 v164, 16, v164
    v_mul_f32 v164, v164, v167
    v_and_b32 v6, 12, v1
    v_add_u32 v6, v6, v2
    v_cmp_gt_u32 s[88:89], 14, v6
    v_min_u32 v6, 13, v6
    v_and_b32 v7, 3, v1
    v_lshlrev_b32 v36, 6, v7
    v_mul_u32_u24 v7, 7168, v7
    v_lshl_add_u32 v15, v6, 2, v7
    s_mul_i32 s70, s63, 28672
    s_mul_i32 s71, s64, 56
    s_add_u32 s70, s70, s71
    s_add_u32 s70, s70, 0x10000
    s_add_u32 s71, s70, 3584
    v_lshlrev_b32 v4, 2, v0
    s_mov_b32 exec_hi, 0
    ds_write_b32 v4, v164 offset:38912
    s_mov_b64 exec, -1
    v_lshrrev_b32 v6, 3, v1
    v_lshl_add_u32 v6, v6, 2, v2
    v_lshlrev_b32 v6, 15, v6
    v_and_b32 v7, 7, v1
    v_lshl_add_u32 v4, v7, 4, v6
    s_lshl_b32 s67, s62, 18
    s_lshl_b32 s66, s61, 7
    s_add_u32 s67, s67, s66
    s_add_u32 s67, s67, 0x40000
    v_lshlrev_b32 v13, 7, v1
    v_lshl_add_u32 v14, v2, 4, v13
    s_lshl_b32 s72, s62, 6
    v_add_u32 v12, s72, v3
    s_lshl_b32 s72, s62, 3
    v_mov_b32 v11, s72
s_pml:
    buffer_load_dword v24, v15, s[56:59], s70 offen sc1
    buffer_load_dword v25, v15, s[56:59], s71 offen sc1
    buffer_load_dword v26, v36, s[52:55], 0 offen offset:4 sc1
    s_waitcnt vmcnt(0)
    v_add_u32 v26, -1, v26
    v_max3_u32 v6, v24, v25, v26
    v_cmp_eq_u32 vcc, -1, v6
    s_cbranch_vccz s_pml_d
    s_mov_b64 exec, vcc
    s_sub_u32 s91, s91, 1
    s_cbranch_scc0 s_pml
    s_endpgm
s_pml_d:
    s_mov_b64 exec, -1
    v_add_f32_dpp v24, v24, v24 quad_perm:[1,0,3,2] row_mask:0xf bank_mask:0xf
    v_add_f32_dpp v25, v25, v25 quad_perm:[1,0,3,2] row_mask:0xf bank_mask:0xf
    s_nop 0
    v_add_f32_dpp v24, v24, v24 quad_perm:[2,3,0,1] row_mask:0xf bank_mask:0xf
    v_add_f32_dpp v25, v25, v25 quad_perm:[2,3,0,1] row_mask:0xf bank_mask:0xf
    v_cvt_pk_bf16_f32 v24, v24, v24
    v_lshlrev_b32 v24, 16, v24
    v_cvt_pk_bf16_f32 v25, v25, v25
    v_lshlrev_b32 v25, 16, v25
    v_mul_f32 v26, 0xbfb8aa3b, v24
    v_exp_f32 v26, v26
    s_nop 0
    v_add_f32 v26, 1.0, v26
    v_rcp_f32 v26, v26
    s_nop 0
    v_mul_f32 v26, v26, v24
    v_cvt_pk_bf16_f32 v26, v26, v26
    v_lshlrev_b32 v26, 16, v26
    v_mul_f32 v26, v26, v25
    v_cvt_pk_bf16_f32 v26, v26, v26
    v_cndmask_b32 v26, 0, v26, s[88:89]
    s_nop 1
    v_mov_b32_dpp v28, v26 row_newbcast:0 row_mask:0xf bank_mask:0xf
    v_mov_b32_dpp v29, v26 row_newbcast:4 row_mask:0xf bank_mask:0xf
    v_mov_b32_dpp v30, v26 row_newbcast:8 row_mask:0xf bank_mask:0xf
    v_mov_b32_dpp v31, v26 row_newbcast:12 row_mask:0xf bank_mask:0xf
    v_mul_u32_u24_sdwa v104, v28, v156 dst_sel:DWORD dst_unused:UNUSED_PAD src0_sel:WORD_0 src1_sel:DWORD
    v_mul_u32_u24_sdwa v105, v28, v157 dst_sel:DWORD dst_unused:UNUSED_PAD src0_sel:WORD_0 src1_sel:DWORD
    v_mul_u32_u24_sdwa v106, v28, v158 dst_sel:DWORD dst_unused:UNUSED_PAD src0_sel:WORD_0 src1_sel:DWORD
    v_mul_u32_u24_sdwa v107, v28, v159 dst_sel:DWORD dst_unused:UNUSED_PAD src0_sel:WORD_0 src1_sel:DWORD
    v_mul_u32_u24_sdwa v108, v29, v156 dst_sel:DWORD dst_unused:UNUSED_PAD src0_sel:WORD_0 src1_sel:DWORD
    v_mul_u32_u24_sdwa v109, v29, v157 dst_sel:DWORD dst_unused:UNUSED_PAD src0_sel:WORD_0 src1_sel:DWORD
    v_mul_u32_u24_sdwa v110, v29, v158 dst_sel:DWORD dst_unused:UNUSED_PAD src0_sel:WORD_0 src1_sel:DWORD
    v_mul_u32_u24_sdwa v111, v29, v159 dst_sel:DWORD dst_unused:UNUSED_PAD src0_sel:WORD_0 src1_sel:DWORD
    v_mul_u32_u24_sdwa v112, v30, v156 dst_sel:DWORD dst_unused:UNUSED_PAD src0_sel:WORD_0 src1_sel:DWORD
    v_mul_u32_u24_sdwa v113, v30, v157 dst_sel:DWORD dst_unused:UNUSED_PAD src0_sel:WORD_0 src1_sel:DWORD
    v_mul_u32_u24_sdwa v114, v30, v158 dst_sel:DWORD dst_unused:UNUSED_PAD src0_sel:WORD_0 src1_sel:DWORD
    v_mul_u32_u24_sdwa v115, v30, v159 dst_sel:DWORD dst_unused:UNUSED_PAD src0_sel:WORD_0 src1_sel:DWORD
    v_mul_u32_u24_sdwa v116, v31, v156 dst_sel:DWORD dst_unused:UNUSED_PAD src0_sel:WORD_0 src1_sel:DWORD
    v_mul_u32_u24_sdwa v117, v31, v157 dst_sel:DWORD dst_unused:UNUSED_PAD src0_sel:WORD_0 src1_sel:DWORD
    v_mul_u32_u24_sdwa v118, v31, v158 dst_sel:DWORD dst_unused:UNUSED_PAD src0_sel:WORD_0 src1_sel:DWORD
    v_mul_u32_u24_sdwa v119, v31, v159 dst_sel:DWORD dst_unused:UNUSED_PAD src0_sel:WORD_0 src1_sel:DWORD
    v_mfma_f32_16x16x32_bf16 v[144:147], v[40:43], v[104:107], 0
    v_mfma_f32_16x16x32_bf16 v[148:151], v[44:47], v[104:107], 0
    v_mfma_f32_16x16x32_bf16 v[144:147], v[48:51], v[108:111], v[144:147]
    v_mfma_f32_16x16x32_bf16 v[148:151], v[52:55], v[108:111], v[148:151]
    v_mfma_f32_16x16x32_bf16 v[144:147], v[56:59], v[112:115], v[144:147]
    v_mfma_f32_16x16x32_bf16 v[148:151], v[60:63], v[112:115], v[148:151]
    v_mfma_f32_16x16x32_bf16 v[144:147], v[64:67], v[116:119], v[144:147]
    v_mfma_f32_16x16x32_bf16 v[148:151], v[68:71], v[116:119], v[148:151]
    s_nop 6
    v_mul_f32 v144, v144, v166
    v_mul_f32 v145, v145, v166
    v_mul_f32 v146, v146, v166
    v_mul_f32 v147, v147, v166
    v_mul_f32_dpp v144, v148, v166 quad_perm:[0,1,2,3] row_mask:0xf bank_mask:0xc
    v_mul_f32_dpp v145, v149, v166 quad_perm:[0,1,2,3] row_mask:0xf bank_mask:0xc
    v_mul_f32_dpp v146, v150, v166 quad_perm:[0,1,2,3] row_mask:0xf bank_mask:0xc
    v_mul_f32_dpp v147, v151, v166 quad_perm:[0,1,2,3] row_mask:0xf bank_mask:0xc
s_so:
    ds_read_b32 v6, v9 offset:20
    s_waitcnt lgkmcnt(0)
    v_readfirstlane_b32 s92, v6
    s_cmp_ge_u32 s92, 8
    s_cbranch_scc1 s_so_d
    s_sub_u32 s90, s90, 1
    s_cbranch_scc0 s_so
    s_endpgm
s_so_d:
s_pap:
    buffer_load_dwordx4 v[16:19], v14, s[56:59], s68 offen sc1
    buffer_load_dwordx2 v[20:21], v13, s[56:59], s68 offen offset:64 sc1
    s_waitcnt vmcnt(0)
    v_max3_u32 v6, v16, v17, v18
    v_max3_u32 v6, v6, v19, v20
    v_max_u32 v6, v6, v21
    v_cmp_eq_u32 vcc, -1, v6
    s_cbranch_vccz s_pap_d
    s_mov_b64 exec, vcc
    s_sub_u32 s91, s91, 1
    s_cbranch_scc0 s_pap
    s_endpgm
s_pap_d:
    s_mov_b64 exec, -1
    v_max_f32_dpp v22, v20, v20 quad_perm:[1,0,3,2] row_mask:0xf bank_mask:0xf
    s_nop 1
    v_max_f32_dpp v22, v22, v22 quad_perm:[2,3,0,1] row_mask:0xf bank_mask:0xf
    s_nop 1
    v_max_f32_dpp v22, v22, v22 row_ror:4 row_mask:0xf bank_mask:0xf
    s_nop 1
    v_max_f32_dpp v22, v22, v22 row_ror:8 row_mask:0xf bank_mask:0xf
    v_sub_f32 v20, v20, v22
    v_exp_f32 v20, v20
    s_nop 0
    v_mul_f32 v23, v21, v20
    v_mul_f32 v16, v16, v20
    v_mul_f32 v17, v17, v20
    v_mul_f32 v18, v18, v20
    v_mul_f32 v19, v19, v20
    v_add_f32_dpp v23, v23, v23 quad_perm:[1,0,3,2] row_mask:0xf bank_mask:0xf
    v_add_f32_dpp v16, v16, v16 quad_perm:[1,0,3,2] row_mask:0xf bank_mask:0xf
    v_add_f32_dpp v17, v17, v17 quad_perm:[1,0,3,2] row_mask:0xf bank_mask:0xf
    v_add_f32_dpp v18, v18, v18 quad_perm:[1,0,3,2] row_mask:0xf bank_mask:0xf
    v_add_f32_dpp v19, v19, v19 quad_perm:[1,0,3,2] row_mask:0xf bank_mask:0xf
    v_add_f32_dpp v23, v23, v23 quad_perm:[2,3,0,1] row_mask:0xf bank_mask:0xf
    v_add_f32_dpp v16, v16, v16 quad_perm:[2,3,0,1] row_mask:0xf bank_mask:0xf
    v_add_f32_dpp v17, v17, v17 quad_perm:[2,3,0,1] row_mask:0xf bank_mask:0xf
    v_add_f32_dpp v18, v18, v18 quad_perm:[2,3,0,1] row_mask:0xf bank_mask:0xf
    v_add_f32_dpp v19, v19, v19 quad_perm:[2,3,0,1] row_mask:0xf bank_mask:0xf
    v_add_f32_dpp v23, v23, v23 row_ror:4 row_mask:0xf bank_mask:0xf
    v_add_f32_dpp v16, v16, v16 row_ror:4 row_mask:0xf bank_mask:0xf
    v_add_f32_dpp v17, v17, v17 row_ror:4 row_mask:0xf bank_mask:0xf
    v_add_f32_dpp v18, v18, v18 row_ror:4 row_mask:0xf bank_mask:0xf
    v_add_f32_dpp v19, v19, v19 row_ror:4 row_mask:0xf bank_mask:0xf
    v_add_f32_dpp v23, v23, v23 row_ror:8 row_mask:0xf bank_mask:0xf
    v_add_f32_dpp v16, v16, v16 row_ror:8 row_mask:0xf bank_mask:0xf
    v_add_f32_dpp v17, v17, v17 row_ror:8 row_mask:0xf bank_mask:0xf
    v_add_f32_dpp v18, v18, v18 row_ror:8 row_mask:0xf bank_mask:0xf
    v_add_f32_dpp v19, v19, v19 row_ror:8 row_mask:0xf bank_mask:0xf
    s_mov_b32 exec_lo, 0x00010001
    s_mov_b32 exec_hi, 0x00010001
    ds_write_b128 v12, v[16:19] offset:3328
    s_mov_b64 exec, 1
    ds_write_b64 v11, v[22:23] offset:3264
    s_mov_b64 exec, 1
    ds_add_u32 v9, v10 offset:28
    s_mov_b64 exec, -1
s_sc:
    ds_read_b32 v6, v9 offset:28
    s_waitcnt lgkmcnt(0)
    v_readfirstlane_b32 s92, v6
    s_cmp_ge_u32 s92, 4
    s_cbranch_scc1 s_sc_d
    s_sub_u32 s90, s90, 1
    s_cbranch_scc0 s_sc
    s_endpgm
s_sc_d:
    ds_read_b128 v[32:35], v9 offset:3264
    ds_read_b128 v[36:39], v9 offset:3280
    ds_read_b128 v[16:19], v3 offset:3328
    ds_read_b128 v[20:23], v3 offset:3392
    ds_read_b128 v[24:27], v3 offset:3456
    ds_read_b128 v[28:31], v3 offset:3520
    s_waitcnt lgkmcnt(4)
    v_max3_f32 v6, v32, v34, v36
    v_max_f32 v6, v6, v38
    v_sub_f32 v32, v32, v6
    v_sub_f32 v34, v34, v6
    v_sub_f32 v36, v36, v6
    v_sub_f32 v38, v38, v6
    v_exp_f32 v32, v32
    v_exp_f32 v34, v34
    v_exp_f32 v36, v36
    v_exp_f32 v38, v38
    v_mul_f32 v6, v32, v33
    v_mul_f32 v7, v34, v35
    v_fmac_f32 v6, v36, v37
    v_fmac_f32 v7, v38, v39
    v_add_f32 v6, v6, v7
    v_rcp_f32 v6, v6
    s_waitcnt lgkmcnt(0)
    v_mul_f32 v16, v16, v32
    v_mul_f32 v24, v24, v36
    v_mul_f32 v17, v17, v32
    v_mul_f32 v25, v25, v36
    v_mul_f32 v18, v18, v32
    v_mul_f32 v26, v26, v36
    v_mul_f32 v19, v19, v32
    v_mul_f32 v27, v27, v36
    v_fmac_f32 v16, v20, v34
    v_fmac_f32 v24, v28, v38
    v_fmac_f32 v17, v21, v34
    v_fmac_f32 v25, v29, v38
    v_fmac_f32 v18, v22, v34
    v_fmac_f32 v26, v30, v38
    v_fmac_f32 v19, v23, v34
    v_fmac_f32 v27, v31, v38
    v_add_f32 v16, v16, v24
    v_add_f32 v17, v17, v25
    v_add_f32 v18, v18, v26
    v_add_f32 v19, v19, v27
    v_mul_f32 v16, v16, v6
    v_mul_f32 v17, v17, v6
    v_mul_f32 v18, v18, v6
    v_mul_f32 v19, v19, v6
    v_cvt_pk_bf16_f32 v16, v16, v17
    v_cvt_pk_bf16_f32 v17, v18, v19
    v_mul_u32_u24_sdwa v120, v16, v156 dst_sel:DWORD dst_unused:UNUSED_PAD src0_sel:WORD_0 src1_sel:DWORD
    v_mul_u32_u24_sdwa v121, v16, v157 dst_sel:DWORD dst_unused:UNUSED_PAD src0_sel:WORD_0 src1_sel:DWORD
    v_mul_u32_u24_sdwa v122, v16, v158 dst_sel:DWORD dst_unused:UNUSED_PAD src0_sel:WORD_0 src1_sel:DWORD
    v_mul_u32_u24_sdwa v123, v16, v159 dst_sel:DWORD dst_unused:UNUSED_PAD src0_sel:WORD_0 src1_sel:DWORD
    s_nop 1
    v_mfma_f32_16x16x32_bf16 v[148:151], v[72:75], v[120:123], 0
    v_mfma_f32_16x16x32_bf16 v[152:155], v[76:79], v[120:123], 0
    v_mul_u32_u24_sdwa v124, v16, v156 dst_sel:DWORD dst_unused:UNUSED_PAD src0_sel:WORD_1 src1_sel:DWORD
    v_mul_u32_u24_sdwa v125, v16, v157 dst_sel:DWORD dst_unused:UNUSED_PAD src0_sel:WORD_1 src1_sel:DWORD
    v_mul_u32_u24_sdwa v126, v16, v158 dst_sel:DWORD dst_unused:UNUSED_PAD src0_sel:WORD_1 src1_sel:DWORD
    v_mul_u32_u24_sdwa v127, v16, v159 dst_sel:DWORD dst_unused:UNUSED_PAD src0_sel:WORD_1 src1_sel:DWORD
    s_nop 1
    v_mfma_f32_16x16x32_bf16 v[148:151], v[80:83], v[124:127], v[148:151]
    v_mfma_f32_16x16x32_bf16 v[152:155], v[84:87], v[124:127], v[152:155]
    v_mul_u32_u24_sdwa v128, v17, v156 dst_sel:DWORD dst_unused:UNUSED_PAD src0_sel:WORD_0 src1_sel:DWORD
    v_mul_u32_u24_sdwa v129, v17, v157 dst_sel:DWORD dst_unused:UNUSED_PAD src0_sel:WORD_0 src1_sel:DWORD
    v_mul_u32_u24_sdwa v130, v17, v158 dst_sel:DWORD dst_unused:UNUSED_PAD src0_sel:WORD_0 src1_sel:DWORD
    v_mul_u32_u24_sdwa v131, v17, v159 dst_sel:DWORD dst_unused:UNUSED_PAD src0_sel:WORD_0 src1_sel:DWORD
    s_nop 1
    v_mfma_f32_16x16x32_bf16 v[148:151], v[88:91], v[128:131], v[148:151]
    v_mfma_f32_16x16x32_bf16 v[152:155], v[92:95], v[128:131], v[152:155]
    v_mul_u32_u24_sdwa v132, v17, v156 dst_sel:DWORD dst_unused:UNUSED_PAD src0_sel:WORD_1 src1_sel:DWORD
    v_mul_u32_u24_sdwa v133, v17, v157 dst_sel:DWORD dst_unused:UNUSED_PAD src0_sel:WORD_1 src1_sel:DWORD
    v_mul_u32_u24_sdwa v134, v17, v158 dst_sel:DWORD dst_unused:UNUSED_PAD src0_sel:WORD_1 src1_sel:DWORD
    v_mul_u32_u24_sdwa v135, v17, v159 dst_sel:DWORD dst_unused:UNUSED_PAD src0_sel:WORD_1 src1_sel:DWORD
    s_nop 1
    v_mfma_f32_16x16x32_bf16 v[148:151], v[96:99], v[132:135], v[148:151]
    v_mfma_f32_16x16x32_bf16 v[152:155], v[100:103], v[132:135], v[152:155]
    s_nop 6
    v_fmac_f32_dpp v144, v148, v165 quad_perm:[0,1,2,3] row_mask:0xf bank_mask:0x3
    v_fmac_f32_dpp v145, v149, v165 quad_perm:[0,1,2,3] row_mask:0xf bank_mask:0x3
    v_fmac_f32_dpp v146, v150, v165 quad_perm:[0,1,2,3] row_mask:0xf bank_mask:0x3
    v_fmac_f32_dpp v147, v151, v165 quad_perm:[0,1,2,3] row_mask:0xf bank_mask:0x3
    v_fmac_f32_dpp v144, v152, v165 quad_perm:[0,1,2,3] row_mask:0xf bank_mask:0xc
    v_fmac_f32_dpp v145, v153, v165 quad_perm:[0,1,2,3] row_mask:0xf bank_mask:0xc
    v_fmac_f32_dpp v146, v154, v165 quad_perm:[0,1,2,3] row_mask:0xf bank_mask:0xc
    v_fmac_f32_dpp v147, v155, v165 quad_perm:[0,1,2,3] row_mask:0xf bank_mask:0xc
    v_min_u32 v144, -2, v144
    v_min_u32 v145, -2, v145
    v_min_u32 v146, -2, v146
    v_min_u32 v147, -2, v147
    buffer_store_dwordx4 v[144:147], v4, s[56:59], s67 offen sc1
    s_mov_b64 exec, 1
    ds_add_u32 v9, v10 offset:36
    s_mov_b64 exec, -1
k_end:
    s_endpgm
.section .rodata,"a"
.p2align 6
.amdhsa_kernel gated_mix__gqa_block_cached__moe_arch_mod__decode_kernel
  .amdhsa_next_free_vgpr 168
  .amdhsa_next_free_sgpr 100
  .amdhsa_accum_offset 168
  .amdhsa_group_segment_fixed_size 0
  .amdhsa_kernarg_size 112
  .amdhsa_user_sgpr_count 2
  .amdhsa_user_sgpr_kernarg_segment_ptr 1
  .amdhsa_system_sgpr_workgroup_id_x 1
.end_amdhsa_kernel
```
